```python
import torch

def _softmax(x, axis=-1):
    return torch.softmax(x, dim=axis)
def _gelu(x):
    return torch.nn.functional.gelu(x, approximate="tanh")
def _silu(x):
    return torch.nn.functional.silu(x)
def _sigmoid(x):
    return torch.sigmoid(x)
def _layernorm(x, axis=-1, eps=1e-5):
    m = x.mean(dim=axis, keepdim=True)
    v = x.var(dim=axis, keepdim=True, unbiased=False)
    return (x - m) / torch.sqrt(v + eps)
def _scatter_add(tgt, idx, src, axis=0):
    return tgt.clone().index_add_(axis, idx, src)
def _segment_sum(src, seg, n):
    out = torch.zeros((n,) + src.shape[1:], dtype=src.dtype)
    return out.index_add_(0, seg, src)
def _pad(x, pw):
    flat = tuple(v for pair in reversed(pw) for v in pair)
    return torch.nn.functional.pad(x, flat)

kernel_name = 'parallel_sum__ssm_conv_s5__glu_gated_bilinear__prompt'

def setup_inputs():

    _w = (lambda a: (lambda t: t.to(torch.bfloat16) if t.is_floating_point() else t)(torch.as_tensor(a)))
    def _A_setup():
        B, S, D = 1, 2048, 512
        P = D
        Lambda_re = -0.5 * (lambda _x: torch.exp(torch.as_tensor(_x)))((lambda *s: torch.randn(*s, dtype=torch.bfloat16) * 0.2)(P))
        Lambda_im = (lambda *s: torch.randn(*s, dtype=torch.bfloat16) * 0.8)(P) * 1.0
        B_re = (lambda *s: torch.randn(*s, dtype=torch.bfloat16) * 0.2)(P, D) * (D ** -0.5)
        B_im = (lambda *s: torch.randn(*s, dtype=torch.bfloat16) * 0.2)(P, D) * (D ** -0.5)
        C_re = (lambda *s: torch.randn(*s, dtype=torch.bfloat16) * 0.2)(D, P) * (P ** -0.5)
        C_im = (lambda *s: torch.randn(*s, dtype=torch.bfloat16) * 0.2)(D, P) * (P ** -0.5)
        log_dt = (lambda *s: torch.randn(*s, dtype=torch.bfloat16) * 0.2)(P) * 0.3 - 2.0
        Dskip = (lambda *s: torch.randn(*s, dtype=torch.bfloat16) * 0.05)(D)
        return {
            "x": _w((lambda *s: torch.randn(*s, dtype=torch.bfloat16) * 0.05)(B, S, D)),
            "Lambda_re": _w(Lambda_re),
            "Lambda_im": _w(Lambda_im),
            "B_re": _w(B_re),
            "B_im": _w(B_im),
            "C_re": _w(C_re),
            "C_im": _w(C_im),
            "log_dt": _w(log_dt),
            "Dskip": _w(Dskip),
        }
    _A_in = _A_setup()

    def _B_setup():
        B, S, D, F = 1, 2048, 512, 1792
        return {
            "x": _w((lambda *s: torch.randn(*s, dtype=torch.bfloat16) * 0.05)(B, S, D)),
            "w_gate": _w((lambda *s: torch.randn(*s, dtype=torch.bfloat16) * 0.4)(D, F) * (D ** -0.5)),
            "w_up": _w((lambda *s: torch.randn(*s, dtype=torch.bfloat16) * 0.4)(D, F) * (D ** -0.5)),
            "w_down": _w((lambda *s: torch.randn(*s, dtype=torch.bfloat16) * 0.4)(F, D) * (F ** -0.5)),
        }
    _B_in = _B_setup()

    return {
        "A_x": _A_in["x"],
        "A_Lambda_re": _A_in["Lambda_re"],
        "A_Lambda_im": _A_in["Lambda_im"],
        "A_B_re": _A_in["B_re"],
        "A_B_im": _A_in["B_im"],
        "A_C_re": _A_in["C_re"],
        "A_C_im": _A_in["C_im"],
        "A_log_dt": _A_in["log_dt"],
        "A_Dskip": _A_in["Dskip"],
        "B_x": _B_in["x"],
        "B_w_gate": _B_in["w_gate"],
        "B_w_up": _B_in["w_up"],
        "B_w_down": _B_in["w_down"],
    }

def reference(A_x, A_Lambda_re, A_Lambda_im, A_B_re, A_B_im, A_C_re, A_C_im, A_log_dt, A_Dskip, B_x, B_w_gate, B_w_up, B_w_down):
    def _A_ref(x, Lambda_re, Lambda_im, B_re, B_im, C_re, C_im, log_dt, Dskip):
        Bsz, L, H = x.shape
        Lam = Lambda_re + 1j * Lambda_im
        Bmat = B_re + 1j * B_im
        Cmat = C_re + 1j * C_im
        dt = torch.exp(log_dt)
        Lam_bar = torch.exp(dt * Lam)
        B_bar = ((Lam_bar - 1.0) / Lam)[:, None] * Bmat
        Bu = torch.einsum("bld,pd->blp", x + 0j, B_bar)
        h = torch.zeros_like(Bu[:, 0, :])
        hs = []
        for t in range(L):
            h = Lam_bar[None, :] * h + Bu[:, t, :]
            hs.append(h)
        hseq = torch.stack(hs, 1)
        y = 2.0 * torch.einsum("blp,dp->bld", hseq, Cmat).real + x * Dskip[None, None, :]
        return y

    def _B_ref(x, w_gate, w_up, w_down):
        g = torch.einsum("bsd,df->bsf", x, w_gate)
        u = torch.einsum("bsd,df->bsf", x, w_up)
        h = g * u
        return torch.einsum("bsf,fd->bsd", h, w_down)

    x = A_x
    xn = _layernorm(x, axis=-1)
    return x + _A_ref(xn, A_Lambda_re, A_Lambda_im, A_B_re, A_B_im, A_C_re, A_C_im, A_log_dt, A_Dskip) + _B_ref(xn, B_w_gate, B_w_up, B_w_down)
```

```asm
; @launch grid=(256,1,1) block=(256,1,1) lds=163840
.amdgcn_target "amdgcn-amd-amdhsa--gfx950"
.text
.globl parallel_sum__ssm_conv_s5__glu_gated_bilinear__prompt_kernel
.p2align 8
.type parallel_sum__ssm_conv_s5__glu_gated_bilinear__prompt_kernel,@function
parallel_sum__ssm_conv_s5__glu_gated_bilinear__prompt_kernel:
    s_cmp_ge_u32 s2, 256
    s_cbranch_scc1 L_end
    s_load_dwordx16 s[16:31], s[0:1], 0
    s_load_dwordx16 s[32:47], s[0:1], 64
    v_lshrrev_b32 v3, 6, v0
    v_and_b32 v1, 63, v0
    v_readfirstlane_b32 s3, v3
    v_lshrrev_b32 v2, 5, v1
    s_getpc_b64 s[8:9]
L_pc:
    s_lshr_b32 s10, s2, 3
    s_lshl_b32 s10, s10, 10
    v_lshl_add_u32 v64, v0, 2, s10
    v_min_u32 v64, L_end-L_pc-4, v64
    global_load_dword a213, v64, s[8:9]
    s_and_b32 s8, s2, 7
    s_lshr_b32 s9, s2, 3
    s_and_b32 s4, s8, 1
    s_lshl_b32 s4, s4, 3
    s_and_b32 s10, s9, 7
    s_add_u32 s4, s4, s10
    s_lshr_b32 s6, s8, 1
    s_lshr_b32 s7, s9, 3
    s_lshl_b32 s5, s6, 2
    s_add_u32 s5, s5, s7
    s_lshl_b32 s13, s3, 13
    v_bfe_u32 v64, v1, 4, 1
    v_lshl_add_u32 v64, v64, 2, v2
    v_and_b32 v65, 7, v1
    v_xor_b32 v64, v64, v65
    v_lshlrev_b32 v64, 4, v64
    v_bfe_u32 v66, v1, 3, 2
    v_lshl_add_u32 v66, v2, 4, v66
    v_lshl_add_u32 v4, v66, 10, v64
    v_xor_b32 v5, 32, v4
    v_add_u32 v5, 3072, v5
    v_add_u32 v6, 6144, v4
    v_add_u32 v7, 6144, v5
    v_lshrrev_b32 v67, 3, v1
    v_lshl_add_u32 v8, v67, 10, v64
    s_lshl_b32 s94, s4, 17
    s_lshl_b32 s10, s3, 15
    s_add_u32 s94, s94, s10
    s_mul_i32 s100, s7, 1
    s_add_u32 s100, s100, s4
    s_and_b32 s100, s100, 7
    s_lshl_b32 s95, s100, 7
    v_and_b32 v64, 31, v1
    s_lshl_b32 s10, s5, 6
    v_lshl_add_u32 v64, v64, 1, s10
    v_xor_b32 v9, 32, v8
    v_add_u32 v9, 7168, v9
    v_add_u32 v10, 14336, v8
    v_add_u32 v11, 14336, v9
    s_add_u32 s10, s100, s3
    s_and_b32 s10, s10, 7
    s_lshl_b32 s10, s10, 7
    s_lshl_b32 s88, s5, 15
    s_add_u32 s88, s88, s10
    s_and_b32 s10, s4, 7
    s_lshl_b32 s10, s10, 7
    s_lshl_b32 s11, s5, 15
    s_add_u32 s10, s10, s11
    s_lshr_b32 s11, s3, 1
    s_lshl_b32 s11, s11, 14
    s_add_u32 s10, s10, s11
    v_and_b32 v66, 15, v1
    v_lshl_add_u32 v66, v66, 10, s10
    s_mov_b32 s50, 0x200000
    s_mov_b32 s51, 0x20000
    s_waitcnt lgkmcnt(0)
    s_mov_b32 s48, s16
    s_mov_b32 s49, s17
    s_add_u32 m0, s13, 0x0
    s_add_u32 s98, s94, s95
    buffer_load_dwordx4 v4, s[48:51], s98 offen offset:0 lds
    s_or_b32 s12, s2, s3
    v_mov_b32 v65, 0x17a0000
    s_cbranch_scc1 L_nolead1
    global_load_dword v75, v65, s[46:47] sc1
L_nolead1:
    global_load_ushort v72, v64, s[18:19]
    global_load_ushort v73, v64, s[20:21]
    global_load_ushort v74, v64, s[30:31]
    s_bitcmp1_b32 s3, 0
    s_cselect_b32 s8, s24, s22
    s_cselect_b32 s9, s25, s23
    global_load_dword a214, v66, s[8:9]
    buffer_load_dwordx4 v5, s[48:51], s98 offen offset:1024 lds
    buffer_load_dwordx4 v6, s[48:51], s98 offen offset:2048 lds
    buffer_load_dwordx4 v7, s[48:51], s98 offen offset:3072 lds
    s_add_u32 s95, s95, 128
    s_and_b32 s95, s95, 1023
    s_add_u32 m0, s13, 0x1000
    s_add_u32 s98, s94, s95
    buffer_load_dwordx4 v4, s[48:51], s98 offen offset:0 lds
    buffer_load_dwordx4 v5, s[48:51], s98 offen offset:1024 lds
    buffer_load_dwordx4 v6, s[48:51], s98 offen offset:2048 lds
    buffer_load_dwordx4 v7, s[48:51], s98 offen offset:3072 lds
    s_add_u32 s95, s95, 128
    s_and_b32 s95, s95, 1023
    s_mov_b32 s52, s22
    s_mov_b32 s53, s23
    s_mov_b32 s54, 0x80000
    s_mov_b32 s55, 0x20000
    s_mov_b32 s56, s24
    s_mov_b32 s57, s25
    s_mov_b32 s58, 0x80000
    s_mov_b32 s59, 0x20000
    s_add_u32 m0, s13, 0x8000
    s_add_u32 s98, s94, s95
    buffer_load_dwordx4 v4, s[48:51], s98 offen offset:0 lds
    buffer_load_dwordx4 v5, s[48:51], s98 offen offset:1024 lds
    v_lshlrev_b32 v31, 4, v1
    s_mov_b32 s14, 0xffff0000
    s_mov_b32 s15, 0x3f803f80
    s_mov_b32 s96, 0
    s_mov_b32 s97, -1
    s_mov_b32 s80, s46
    s_mov_b32 s81, s47
    s_mov_b32 s82, 0x17a1000
    s_mov_b32 s83, 0x20000
    s_lshl_b32 s10, s5, 13
    s_add_u32 s10, s10, 0x1780000
    s_add_u32 s84, s46, s10
    s_addc_u32 s85, s47, 0
    s_mov_b32 s86, 8192
    s_mov_b32 s87, 0x20000
    s_lshl_b32 s9, s4, 2
    s_add_u32 s9, s9, s3
    s_lshl_b32 s9, s9, 4
    s_add_u32 s9, s9, s5
    s_lshl_b32 s10, s9, 8
    s_add_u32 s10, s10, 0x1700000
    v_mov_b32 v64, 0x7ff00000
    v_add_u32 v65, s10, v31
    v_cmp_gt_u32 vcc, 8, v1
    v_add_u32 v67, 1, v1
    v_lshlrev_b32 v66, 2, v1
    v_cndmask_b32 v3, v64, v65, vcc
    v_cmp_lt_u32 vcc, 2, v1
    v_subrev_u32 v66, 8, v66
    v_and_b32 v66, 15, v66
    v_cndmask_b32 v67, v67, v66, vcc
    v_lshlrev_b32 v67, 8, v67
    v_xor_b32 v35, s10, v67
    s_lshl_b32 s10, s4, 9
    v_and_b32 v67, 31, v1
    v_cmp_le_u32 vcc, 224, v0
    v_lshl_add_u32 v67, v67, 4, s10
    s_nop 0
    v_cndmask_b32 v19, v64, v67, vcc
    v_accvgpr_write_b32 a208, -1
    v_accvgpr_write_b32 a209, -1
    v_accvgpr_write_b32 a210, -1
    v_accvgpr_write_b32 a211, -1
    s_mul_i32 s90, s9, 11264
    s_add_u32 s20, s90, 4096
    s_add_u32 s17, s90, 8192
    v_bfe_u32 v64, v1, 1, 1
    v_bfe_u32 v65, v1, 2, 2
    v_lshl_add_u32 v64, v64, 2, v65
    v_xor_b32 v64, v64, v2
    v_lshlrev_b32 v64, 4, v64
    v_and_b32 v65, 31, v1
    v_lshl_add_u32 v20, v65, 7, v64
    v_xor_b32 v21, 32, v20
    v_xor_b32 v22, 64, v20
    v_xor_b32 v23, 96, v20
    s_add_u32 s8, s13, 0x10000
    v_add_u32 v52, 0x20000, v20
    v_add_u32 v80, s13, v20
    v_add_u32 v84, s8, v20
    v_add_u32 v53, 0x20000, v21
    v_add_u32 v81, s13, v21
    v_add_u32 v85, s8, v21
    v_add_u32 v54, 0x20000, v22
    v_add_u32 v82, s13, v22
    v_add_u32 v86, s8, v22
    v_add_u32 v55, 0x20000, v23
    v_add_u32 v83, s13, v23
    v_add_u32 v87, s8, v23
    s_bitcmp1_b32 s3, 0
    s_cselect_b32 s60, s38, s36
    s_cselect_b32 s61, s39, s37
    s_mov_b32 s62, 0x1c0000
    s_mov_b32 s63, 0x20000
    s_mov_b32 s11, 4682
    v_add_u32 v64, 0, v1
    v_mul_u32_u24 v65, s11, v64
    v_lshrrev_b32 v65, 16, v65
    v_mul_u32_u24 v65, 3360, v65
    v_add_u32 v12, v65, v31
    v_add_u32 v64, 64, v1
    v_mul_u32_u24 v65, s11, v64
    v_lshrrev_b32 v65, 16, v65
    v_mul_u32_u24 v65, 3360, v65
    v_add_u32 v13, v65, v31
    v_add_u32 v64, 128, v1
    v_mul_u32_u24 v65, s11, v64
    v_lshrrev_b32 v65, 16, v65
    v_mul_u32_u24 v65, 3360, v65
    v_add_u32 v14, v65, v31
    v_add_u32 v64, 192, v1
    v_mul_u32_u24 v65, s11, v64
    v_lshrrev_b32 v65, 16, v65
    v_mul_u32_u24 v65, 3360, v65
    v_add_u32 v15, v65, v31
    v_add_u32 v64, 256, v1
    v_mul_u32_u24 v65, s11, v64
    v_lshrrev_b32 v65, 16, v65
    v_mul_u32_u24 v65, 3360, v65
    v_add_u32 v16, v65, v31
    v_add_u32 v16, 4096, v16
    v_add_u32 v64, 320, v1
    v_mul_u32_u24 v65, s11, v64
    v_lshrrev_b32 v65, 16, v65
    v_mul_u32_u24 v65, 3360, v65
    v_add_u32 v17, v65, v31
    v_add_u32 v17, 4096, v17
    v_add_u32 v64, 384, v1
    v_mul_u32_u24 v65, s11, v64
    v_lshrrev_b32 v65, 16, v65
    v_mul_u32_u24 v65, 3360, v65
    v_add_u32 v18, v65, v31
    v_add_u32 v18, 4096, v18
    s_mul_i32 s89, s5, 224
    s_lshr_b32 s10, s3, 1
    s_mul_i32 s11, s10, 114688
    s_add_u32 s89, s89, s11
    s_and_b32 s11, s3, 1
    s_lshl_b32 s8, s11, 7
    s_add_u32 s93, s13, s8
    v_mov_b32 v88, 0
    v_mov_b32 v89, 0
    v_mov_b32 v90, 0
    v_mov_b32 v91, 0
    s_mov_b32 s64, s26
    s_mov_b32 s65, s27
    s_mov_b32 s66, 0x80000
    s_mov_b32 s67, 0x20000
    s_mov_b32 s68, s28
    s_mov_b32 s69, s29
    s_mov_b32 s70, 0x80000
    s_mov_b32 s71, 0x20000
    s_mov_b32 s72, s40
    buffer_load_dwordx4 v6, s[48:51], s98 offen offset:2048 lds
    s_mov_b32 s73, s41
    s_mov_b32 s74, 0x1c0000
    s_mov_b32 s75, 0x20000
    s_mov_b32 s76, s42
    s_mov_b32 s77, s43
    s_mov_b32 s78, 0x400000
    s_mov_b32 s79, 0x20000
    s_cmp_eq_u32 s3, 0
    s_cselect_b32 s18, s26, s28
    s_cselect_b32 s19, s27, s29
    s_and_b32 s8, s4, 7
    s_lshl_b32 s10, s8, 14
    buffer_load_dwordx4 v7, s[48:51], s98 offen offset:3072 lds
    s_add_u32 s95, s95, 128
    s_and_b32 s95, s95, 1023
    s_lshl_b32 s11, s7, 17
    s_add_u32 s10, s10, s11
    s_lshl_b32 s11, s6, 8
    s_add_u32 s10, s10, s11
    s_lshl_b32 s8, s8, 1
    s_and_b32 s11, s3, 1
    s_add_u32 s8, s8, s11
    s_mul_i32 s8, s8, 28672
    s_mul_i32 s11, s6, 458752
    s_add_u32 s8, s8, s11
    s_add_u32 m0, s13, 0x9000
    s_add_u32 s98, s94, s95
    buffer_load_dwordx4 v4, s[48:51], s98 offen offset:0 lds
    s_waitcnt vmcnt(9)
    ds_read_b128 v[128:131], v80 offset:0
    ds_read_b128 v[132:135], v81 offset:0
    ds_read_b128 v[136:139], v82 offset:0
    ds_read_b128 v[140:143], v83 offset:0
    s_waitcnt lgkmcnt(0)
    s_lshl_b32 s11, s7, 8
    s_add_u32 s8, s8, s11
    s_cmp_ge_u32 s3, 2
    s_cselect_b32 s18, s40, s18
    s_cselect_b32 s19, s41, s19
    s_cselect_b32 s10, s8, s10
    s_cselect_b32 s11, 55, 31
    v_min_u32 v64, s11, v1
    v_lshrrev_b32 v65, 1, v64
    v_and_b32 v64, 1, v64
    v_lshlrev_b32 v64, 7, v64
    v_lshl_add_u32 v64, v65, 10, v64
    v_add_u32 v69, s10, v64
    s_lshl_b32 s8, s7, 8
    buffer_load_dwordx4 v5, s[48:51], s98 offen offset:1024 lds
    s_lshl_b32 s10, s6, 6
    s_add_u32 s8, s8, s10
    s_add_u32 s29, s94, s8
    s_lshl_b32 s36, s29, 1
    s_add_u32 s32, s32, s8
    s_addc_u32 s33, s33, 0
    s_xor_b32 s10, s9, 1
    s_mul_i32 s22, s10, 11264
    s_xor_b32 s10, s9, 2
    s_mul_i32 s23, s10, 11264
    s_xor_b32 s10, s9, 3
    buffer_load_dwordx4 v6, s[48:51], s98 offen offset:2048 lds
    s_mul_i32 s24, s10, 11264
    s_xor_b32 s10, s9, 12
    s_mul_i32 s25, s10, 9216
    s_add_u32 s25, s25, 0xb00000
    s_waitcnt vmcnt(7)
    ds_read_b128 v[144:147], v80 offset:4096
    ds_read_b128 v[148:151], v81 offset:4096
    ds_read_b128 v[152:155], v82 offset:4096
    ds_read_b128 v[156:159], v83 offset:4096
    v_dot2c_f32_bf16 v88, s15, v128
    v_dot2c_f32_bf16 v90, v128, v128
    v_dot2c_f32_bf16 v89, s15, v129
    v_dot2c_f32_bf16 v91, v129, v129
    v_dot2c_f32_bf16 v88, s15, v130
    v_dot2c_f32_bf16 v90, v130, v130
    buffer_load_dwordx4 v7, s[48:51], s98 offen offset:3072 lds
    s_add_u32 s95, s95, 128
    s_and_b32 s95, s95, 1023
    v_dot2c_f32_bf16 v89, s15, v131
    v_dot2c_f32_bf16 v91, v131, v131
    v_dot2c_f32_bf16 v88, s15, v132
    v_dot2c_f32_bf16 v90, v132, v132
    v_dot2c_f32_bf16 v89, s15, v133
    v_dot2c_f32_bf16 v91, v133, v133
    v_dot2c_f32_bf16 v88, s15, v134
    v_dot2c_f32_bf16 v90, v134, v134
    v_dot2c_f32_bf16 v89, s15, v135
    v_dot2c_f32_bf16 v91, v135, v135
    s_add_u32 m0, s13, 0x10000
    s_add_u32 s98, s94, s95
    buffer_load_dwordx4 v4, s[48:51], s98 offen offset:0 lds
    v_dot2c_f32_bf16 v88, s15, v136
    v_dot2c_f32_bf16 v90, v136, v136
    v_dot2c_f32_bf16 v89, s15, v137
    v_dot2c_f32_bf16 v91, v137, v137
    v_dot2c_f32_bf16 v88, s15, v138
    v_dot2c_f32_bf16 v90, v138, v138
    v_dot2c_f32_bf16 v89, s15, v139
    v_dot2c_f32_bf16 v91, v139, v139
    v_dot2c_f32_bf16 v88, s15, v140
    v_dot2c_f32_bf16 v90, v140, v140
    buffer_load_dwordx4 v5, s[48:51], s98 offen offset:1024 lds
    v_dot2c_f32_bf16 v89, s15, v141
    v_dot2c_f32_bf16 v91, v141, v141
    v_dot2c_f32_bf16 v88, s15, v142
    v_dot2c_f32_bf16 v90, v142, v142
    v_dot2c_f32_bf16 v89, s15, v143
    v_dot2c_f32_bf16 v91, v143, v143
    s_waitcnt lgkmcnt(0)
    s_xor_b32 s10, s9, 8
    s_mul_i32 s26, s10, 9216
    s_add_u32 s26, s26, 0xb00c00
    s_xor_b32 s10, s9, 4
    buffer_load_dwordx4 v6, s[48:51], s98 offen offset:2048 lds
    s_mul_i32 s27, s10, 9216
    s_add_u32 s27, s27, 0xb01800
    s_mul_i32 s28, s9, 9216
    s_add_u32 s28, s28, 0xb00000
    s_lshr_b32 s10, s3, 1
    s_and_b32 s11, s3, 1
    s_mul_i32 s101, s10, 7168
    s_lshl_b32 s8, s11, 14
    s_add_u32 s101, s101, s8
    s_mul_i32 s92, s6, 458752
    buffer_load_dwordx4 v7, s[48:51], s98 offen offset:3072 lds
    s_add_u32 s95, s95, 128
    s_and_b32 s95, s95, 1023
    s_mul_i32 s8, s10, 57344
    s_add_u32 s92, s92, s8
    s_lshl_b32 s8, s7, 8
    s_add_u32 s92, s92, s8
    s_xor_b32 s8, s6, 3
    s_lshr_b32 s8, s8, 1
    s_lshl_b32 s8, s8, 7
    s_add_u32 s92, s92, s8
    s_cmp_eq_u32 s11, 1
    s_cselect_b32 s8, 0, 0
    s_cselect_b32 s99, 128, 0
    s_xor_b32 s8, s8, s7
    s_add_u32 m0, s13, 0x11000
    s_add_u32 s98, s94, s95
    buffer_load_dwordx4 v4, s[48:51], s98 offen offset:0 lds
    s_waitcnt vmcnt(9)
    ds_read_b128 v[160:163], v80 offset:32768
    ds_read_b128 v[164:167], v81 offset:32768
    ds_read_b128 v[168:171], v82 offset:32768
    ds_read_b128 v[172:175], v83 offset:32768
    v_dot2c_f32_bf16 v88, s15, v144
    v_dot2c_f32_bf16 v90, v144, v144
    v_dot2c_f32_bf16 v89, s15, v145
    v_dot2c_f32_bf16 v91, v145, v145
    v_dot2c_f32_bf16 v88, s15, v146
    v_dot2c_f32_bf16 v90, v146, v146
    v_dot2c_f32_bf16 v89, s15, v147
    v_dot2c_f32_bf16 v91, v147, v147
    v_dot2c_f32_bf16 v88, s15, v148
    v_dot2c_f32_bf16 v90, v148, v148
    buffer_load_dwordx4 v5, s[48:51], s98 offen offset:1024 lds
    v_dot2c_f32_bf16 v89, s15, v149
    v_dot2c_f32_bf16 v91, v149, v149
    v_dot2c_f32_bf16 v88, s15, v150
    v_dot2c_f32_bf16 v90, v150, v150
    v_dot2c_f32_bf16 v89, s15, v151
    v_dot2c_f32_bf16 v91, v151, v151
    v_dot2c_f32_bf16 v88, s15, v152
    v_dot2c_f32_bf16 v90, v152, v152
    v_dot2c_f32_bf16 v89, s15, v153
    v_dot2c_f32_bf16 v91, v153, v153
    buffer_load_dwordx4 v6, s[48:51], s98 offen offset:2048 lds
    v_dot2c_f32_bf16 v88, s15, v154
    v_dot2c_f32_bf16 v90, v154, v154
    v_dot2c_f32_bf16 v89, s15, v155
    v_dot2c_f32_bf16 v91, v155, v155
    v_dot2c_f32_bf16 v88, s15, v156
    v_dot2c_f32_bf16 v90, v156, v156
    v_dot2c_f32_bf16 v89, s15, v157
    v_dot2c_f32_bf16 v91, v157, v157
    v_dot2c_f32_bf16 v88, s15, v158
    v_dot2c_f32_bf16 v90, v158, v158
    buffer_load_dwordx4 v7, s[48:51], s98 offen offset:3072 lds
    s_add_u32 s95, s95, 128
    s_and_b32 s95, s95, 1023
    v_dot2c_f32_bf16 v89, s15, v159
    v_dot2c_f32_bf16 v91, v159, v159
    s_waitcnt lgkmcnt(0)
    s_mul_i32 s8, s8, 114688
    s_xor_b32 s99, s99, s92
    s_add_u32 s37, s8, s99
    s_cmp_eq_u32 s11, 1
    s_cselect_b32 s8, 2, 1
    s_cselect_b32 s99, 0, 0
    s_xor_b32 s8, s8, s7
    s_mul_i32 s8, s8, 114688
    s_xor_b32 s99, s99, s92
    s_add_u32 s38, s8, s99
    s_add_u32 m0, s13, 0x18000
    s_add_u32 s98, s94, s95
    buffer_load_dwordx4 v4, s[48:51], s98 offen offset:0 lds
    s_cmp_eq_u32 s11, 1
    s_cselect_b32 s8, 1, 3
    s_cselect_b32 s99, 128, 0
    s_xor_b32 s8, s8, s7
    s_mul_i32 s8, s8, 114688
    s_xor_b32 s99, s99, s92
    s_add_u32 s39, s8, s99
    s_cmp_eq_u32 s11, 1
    s_cselect_b32 s8, 3, 2
    s_cselect_b32 s99, 128, 128
    s_xor_b32 s8, s8, s7
    s_mul_i32 s8, s8, 114688
    s_xor_b32 s99, s99, s92
    s_add_u32 s40, s8, s99
    buffer_load_dwordx4 v5, s[48:51], s98 offen offset:1024 lds
    s_lshl_b32 s92, s10, 5
    s_and_b32 s8, s6, 1
    s_xor_b32 s8, s8, 1
    s_lshl_b32 s8, s8, 6
    s_or_b32 s92, s92, s8
    s_xor_b32 s8, s3, s6
    s_waitcnt vmcnt(10)
    ds_read_b128 v[176:179], v80 offset:36864
    ds_read_b128 v[180:183], v81 offset:36864
    ds_read_b128 v[184:187], v82 offset:36864
    ds_read_b128 v[188:191], v83 offset:36864
    v_dot2c_f32_bf16 v88, s15, v160
    v_dot2c_f32_bf16 v90, v160, v160
    v_dot2c_f32_bf16 v89, s15, v161
    v_dot2c_f32_bf16 v91, v161, v161
    buffer_load_dwordx4 v6, s[48:51], s98 offen offset:2048 lds
    v_dot2c_f32_bf16 v88, s15, v162
    v_dot2c_f32_bf16 v90, v162, v162
    v_dot2c_f32_bf16 v89, s15, v163
    v_dot2c_f32_bf16 v91, v163, v163
    v_dot2c_f32_bf16 v88, s15, v164
    v_dot2c_f32_bf16 v90, v164, v164
    v_dot2c_f32_bf16 v89, s15, v165
    v_dot2c_f32_bf16 v91, v165, v165
    v_dot2c_f32_bf16 v88, s15, v166
    v_dot2c_f32_bf16 v90, v166, v166
    buffer_load_dwordx4 v7, s[48:51], s98 offen offset:3072 lds
    s_add_u32 s95, s95, 128
    s_and_b32 s95, s95, 1023
    v_dot2c_f32_bf16 v89, s15, v167
    v_dot2c_f32_bf16 v91, v167, v167
    v_dot2c_f32_bf16 v88, s15, v168
    v_dot2c_f32_bf16 v90, v168, v168
    v_dot2c_f32_bf16 v89, s15, v169
    v_dot2c_f32_bf16 v91, v169, v169
    v_dot2c_f32_bf16 v88, s15, v170
    v_dot2c_f32_bf16 v90, v170, v170
    v_dot2c_f32_bf16 v89, s15, v171
    v_dot2c_f32_bf16 v91, v171, v171
    s_add_u32 m0, s13, 0x19000
    s_add_u32 s98, s94, s95
    buffer_load_dwordx4 v4, s[48:51], s98 offen offset:0 lds
    v_dot2c_f32_bf16 v88, s15, v172
    v_dot2c_f32_bf16 v90, v172, v172
    v_dot2c_f32_bf16 v89, s15, v173
    v_dot2c_f32_bf16 v91, v173, v173
    v_dot2c_f32_bf16 v88, s15, v174
    v_dot2c_f32_bf16 v90, v174, v174
    v_dot2c_f32_bf16 v89, s15, v175
    v_dot2c_f32_bf16 v91, v175, v175
    s_waitcnt lgkmcnt(0)
    s_xor_b32 s8, s8, 3
    s_lshl_b32 s91, s8, 15
    buffer_load_dwordx4 v5, s[48:51], s98 offen offset:1024 lds
    s_lshl_b32 s8, s7, 17
    s_add_u32 s91, s91, s8
    s_lshl_b32 s8, s6, 8
    s_add_u32 s91, s91, s8
    s_lshr_b32 s8, s7, 1
    s_lshl_b32 s8, s8, 7
    s_add_u32 s91, s91, s8
    s_and_b32 s8, s7, 1
    s_lshl_b32 s21, s8, 6
    v_bfe_u32 v64, v1, 4, 1
    buffer_load_dwordx4 v6, s[48:51], s98 offen offset:2048 lds
    v_mul_u32_u24 v64, 8320, v64
    v_bfe_u32 v65, v1, 2, 2
    v_lshl_add_u32 v65, v2, 3, v65
    v_mul_u32_u24 v66, 224, v65
    v_add_u32 v64, v64, v66
    v_and_b32 v66, 1, v1
    v_lshl_add_u32 v64, v66, 4, v64
    v_bfe_u32 v67, v1, 1, 1
    v_lshl_add_u32 v24, v67, 3, v64
    v_add_u32 v25, 0x10000, v24
    buffer_load_dwordx4 v7, s[48:51], s98 offen offset:3072 lds
    s_add_u32 s95, s95, 128
    s_and_b32 s95, s95, 1023
    v_add_u32 v26, 0x20000, v24
    v_lshlrev_b32 v65, 7, v65
    s_waitcnt vmcnt(12)
    ds_read_b128 v[192:195], v84 offset:0
    ds_read_b128 v[196:199], v85 offset:0
    ds_read_b128 v[200:203], v86 offset:0
    ds_read_b128 v[204:207], v87 offset:0
    v_dot2c_f32_bf16 v88, s15, v176
    v_dot2c_f32_bf16 v90, v176, v176
    v_dot2c_f32_bf16 v89, s15, v177
    v_dot2c_f32_bf16 v91, v177, v177
    v_dot2c_f32_bf16 v88, s15, v178
    v_dot2c_f32_bf16 v90, v178, v178
    v_dot2c_f32_bf16 v89, s15, v179
    v_dot2c_f32_bf16 v91, v179, v179
    s_add_u32 m0, s13, 0x20000
    s_nop 0
    buffer_load_dwordx4 v8, s[52:55], s88 offen offset:0 lds
    v_dot2c_f32_bf16 v88, s15, v180
    v_dot2c_f32_bf16 v90, v180, v180
    v_dot2c_f32_bf16 v89, s15, v181
    v_dot2c_f32_bf16 v91, v181, v181
    v_dot2c_f32_bf16 v88, s15, v182
    v_dot2c_f32_bf16 v90, v182, v182
    v_dot2c_f32_bf16 v89, s15, v183
    v_dot2c_f32_bf16 v91, v183, v183
    v_dot2c_f32_bf16 v88, s15, v184
    v_dot2c_f32_bf16 v90, v184, v184
    buffer_load_dwordx4 v9, s[52:55], s88 offen offset:1024 lds
    v_dot2c_f32_bf16 v89, s15, v185
    v_dot2c_f32_bf16 v91, v185, v185
    v_dot2c_f32_bf16 v88, s15, v186
    v_dot2c_f32_bf16 v90, v186, v186
    v_dot2c_f32_bf16 v89, s15, v187
    v_dot2c_f32_bf16 v91, v187, v187
    v_dot2c_f32_bf16 v88, s15, v188
    v_dot2c_f32_bf16 v90, v188, v188
    v_dot2c_f32_bf16 v89, s15, v189
    v_dot2c_f32_bf16 v91, v189, v189
    buffer_load_dwordx4 v10, s[52:55], s88 offen offset:2048 lds
    v_dot2c_f32_bf16 v88, s15, v190
    v_dot2c_f32_bf16 v90, v190, v190
    v_dot2c_f32_bf16 v89, s15, v191
    v_dot2c_f32_bf16 v91, v191, v191
    s_waitcnt lgkmcnt(0)
    v_lshl_add_u32 v65, v66, 3, v65
    v_bfe_u32 v64, v1, 3, 1
    v_lshlrev_b32 v64, 2, v64
    v_lshl_add_u32 v64, v2, 1, v64
    v_bfe_u32 v66, v1, 4, 1
    v_lshl_add_u32 v66, v66, 1, v67
    buffer_load_dwordx4 v11, s[52:55], s88 offen offset:3072 lds
    v_xor_b32 v64, v64, v66
    v_lshl_add_u32 v56, v64, 4, v65
    v_xor_b32 v57, 528, v56
    v_xor_b32 v58, 64, v56
    v_xor_b32 v59, 64, v57
    v_add_u32 v60, 0x10000, v56
    v_add_u32 v61, 0x10000, v57
    v_add_u32 v62, 0x10000, v58
    v_add_u32 v63, 0x10000, v59
    v_bfe_u32 v64, v1, 2, 1
    s_add_u32 m0, s13, 0x21000
    s_nop 0
    buffer_load_dwordx4 v8, s[56:59], s88 offen offset:0 lds
    v_bfe_u32 v65, v1, 3, 2
    v_lshlrev_b32 v65, 2, v65
    v_lshl_add_u32 v64, v64, 4, v65
    v_and_b32 v65, 3, v1
    v_add_u32 v27, v64, v65
    s_waitcnt vmcnt(37)
    s_cmp_lg_u32 s12, 0
    s_cbranch_scc1 L_nolead2
    v_mov_b32 v66, 0x17a0000
    s_mov_b32 s10, 1664525
    s_mov_b32 s11, 1013904223
    v_mul_lo_u32 v75, v75, s10
    v_add_u32 v75, s11, v75
    v_mov_b32 v64, s11
    v_add_u32 v65, 1, v75
    v_cmp_gt_u32 vcc, 2, v65
    v_mov_b32 v65, 0
    s_mov_b64 exec, 1
    v_cndmask_b32 v75, v75, v64, vcc
    global_store_dword v65, v75, s[44:45] sc1
    global_store_dword v66, v75, s[46:47] sc1
    s_mov_b64 exec, -1
L_nolead2:
    s_waitcnt vmcnt(13)
    ds_read_b128 v[208:211], v84 offset:4096
    ds_read_b128 v[212:215], v85 offset:4096
    ds_read_b128 v[216:219], v86 offset:4096
    ds_read_b128 v[220:223], v87 offset:4096
    v_dot2c_f32_bf16 v88, s15, v192
    v_dot2c_f32_bf16 v90, v192, v192
    v_dot2c_f32_bf16 v89, s15, v193
    buffer_load_dwordx4 v9, s[56:59], s88 offen offset:1024 lds
    v_dot2c_f32_bf16 v91, v193, v193
    v_dot2c_f32_bf16 v88, s15, v194
    v_dot2c_f32_bf16 v90, v194, v194
    v_dot2c_f32_bf16 v89, s15, v195
    v_dot2c_f32_bf16 v91, v195, v195
    v_dot2c_f32_bf16 v88, s15, v196
    v_dot2c_f32_bf16 v90, v196, v196
    v_dot2c_f32_bf16 v89, s15, v197
    v_dot2c_f32_bf16 v91, v197, v197
    v_dot2c_f32_bf16 v88, s15, v198
    buffer_load_dwordx4 v10, s[56:59], s88 offen offset:2048 lds
    v_dot2c_f32_bf16 v90, v198, v198
    v_dot2c_f32_bf16 v89, s15, v199
    v_dot2c_f32_bf16 v91, v199, v199
    v_dot2c_f32_bf16 v88, s15, v200
    v_dot2c_f32_bf16 v90, v200, v200
    v_dot2c_f32_bf16 v89, s15, v201
    v_dot2c_f32_bf16 v91, v201, v201
    v_dot2c_f32_bf16 v88, s15, v202
    v_dot2c_f32_bf16 v90, v202, v202
    v_dot2c_f32_bf16 v89, s15, v203
    buffer_load_dwordx4 v11, s[56:59], s88 offen offset:3072 lds
    v_dot2c_f32_bf16 v91, v203, v203
    v_dot2c_f32_bf16 v88, s15, v204
    v_dot2c_f32_bf16 v90, v204, v204
    v_dot2c_f32_bf16 v89, s15, v205
    v_dot2c_f32_bf16 v91, v205, v205
    v_dot2c_f32_bf16 v88, s15, v206
    v_dot2c_f32_bf16 v90, v206, v206
    v_dot2c_f32_bf16 v89, s15, v207
    v_dot2c_f32_bf16 v91, v207, v207
    s_waitcnt lgkmcnt(0)
    s_waitcnt vmcnt(12)
    ds_read_b128 v[224:227], v84 offset:32768
    ds_read_b128 v[228:231], v85 offset:32768
    ds_read_b128 v[232:235], v86 offset:32768
    ds_read_b128 v[236:239], v87 offset:32768
    v_dot2c_f32_bf16 v88, s15, v208
    s_xor_b32 s88, s88, 512
    s_add_u32 m0, s13, 0x0
    s_nop 0
    buffer_load_dwordx4 v8, s[52:55], s88 offen offset:0 lds
    v_dot2c_f32_bf16 v90, v208, v208
    v_dot2c_f32_bf16 v89, s15, v209
    v_dot2c_f32_bf16 v91, v209, v209
    v_dot2c_f32_bf16 v88, s15, v210
    v_dot2c_f32_bf16 v90, v210, v210
    v_dot2c_f32_bf16 v89, s15, v211
    v_dot2c_f32_bf16 v91, v211, v211
    v_dot2c_f32_bf16 v88, s15, v212
    v_dot2c_f32_bf16 v90, v212, v212
    v_dot2c_f32_bf16 v89, s15, v213
    buffer_load_dwordx4 v9, s[52:55], s88 offen offset:1024 lds
    v_dot2c_f32_bf16 v91, v213, v213
    v_dot2c_f32_bf16 v88, s15, v214
    v_dot2c_f32_bf16 v90, v214, v214
    v_dot2c_f32_bf16 v89, s15, v215
    v_dot2c_f32_bf16 v91, v215, v215
    v_dot2c_f32_bf16 v88, s15, v216
    v_dot2c_f32_bf16 v90, v216, v216
    v_dot2c_f32_bf16 v89, s15, v217
    v_dot2c_f32_bf16 v91, v217, v217
    v_dot2c_f32_bf16 v88, s15, v218
    buffer_load_dwordx4 v10, s[52:55], s88 offen offset:2048 lds
    v_dot2c_f32_bf16 v90, v218, v218
    v_dot2c_f32_bf16 v89, s15, v219
    v_dot2c_f32_bf16 v91, v219, v219
    v_dot2c_f32_bf16 v88, s15, v220
    v_dot2c_f32_bf16 v90, v220, v220
    v_dot2c_f32_bf16 v89, s15, v221
    v_dot2c_f32_bf16 v91, v221, v221
    v_dot2c_f32_bf16 v88, s15, v222
    v_dot2c_f32_bf16 v90, v222, v222
    v_dot2c_f32_bf16 v89, s15, v223
    buffer_load_dwordx4 v11, s[52:55], s88 offen offset:3072 lds
    v_dot2c_f32_bf16 v91, v223, v223
    s_waitcnt lgkmcnt(0)
    s_waitcnt vmcnt(12)
    ds_read_b128 v[240:243], v84 offset:36864
    ds_read_b128 v[244:247], v85 offset:36864
    ds_read_b128 v[248:251], v86 offset:36864
    ds_read_b128 v[252:255], v87 offset:36864
    v_dot2c_f32_bf16 v88, s15, v224
    v_dot2c_f32_bf16 v90, v224, v224
    v_dot2c_f32_bf16 v89, s15, v225
    v_dot2c_f32_bf16 v91, v225, v225
    v_dot2c_f32_bf16 v88, s15, v226
    v_dot2c_f32_bf16 v90, v226, v226
    v_dot2c_f32_bf16 v89, s15, v227
    v_dot2c_f32_bf16 v91, v227, v227
    v_dot2c_f32_bf16 v88, s15, v228
    s_add_u32 m0, s13, 0x1000
    s_nop 0
    buffer_load_dwordx4 v8, s[56:59], s88 offen offset:0 lds
    v_dot2c_f32_bf16 v90, v228, v228
    v_dot2c_f32_bf16 v89, s15, v229
    v_dot2c_f32_bf16 v91, v229, v229
    v_dot2c_f32_bf16 v88, s15, v230
    v_dot2c_f32_bf16 v90, v230, v230
    v_dot2c_f32_bf16 v89, s15, v231
    v_dot2c_f32_bf16 v91, v231, v231
    v_dot2c_f32_bf16 v88, s15, v232
    v_dot2c_f32_bf16 v90, v232, v232
    v_dot2c_f32_bf16 v89, s15, v233
    buffer_load_dwordx4 v9, s[56:59], s88 offen offset:1024 lds
    v_dot2c_f32_bf16 v91, v233, v233
    v_dot2c_f32_bf16 v88, s15, v234
    v_dot2c_f32_bf16 v90, v234, v234
    v_dot2c_f32_bf16 v89, s15, v235
    v_dot2c_f32_bf16 v91, v235, v235
    v_dot2c_f32_bf16 v88, s15, v236
    v_dot2c_f32_bf16 v90, v236, v236
    v_dot2c_f32_bf16 v89, s15, v237
    v_dot2c_f32_bf16 v91, v237, v237
    v_dot2c_f32_bf16 v88, s15, v238
    buffer_load_dwordx4 v10, s[56:59], s88 offen offset:2048 lds
    v_dot2c_f32_bf16 v90, v238, v238
    v_dot2c_f32_bf16 v89, s15, v239
    v_dot2c_f32_bf16 v91, v239, v239
    s_waitcnt lgkmcnt(0)
    v_dot2c_f32_bf16 v88, s15, v240
    v_dot2c_f32_bf16 v90, v240, v240
    v_dot2c_f32_bf16 v89, s15, v241
    v_dot2c_f32_bf16 v91, v241, v241
    v_dot2c_f32_bf16 v88, s15, v242
    v_dot2c_f32_bf16 v90, v242, v242
    v_dot2c_f32_bf16 v89, s15, v243
    buffer_load_dwordx4 v11, s[56:59], s88 offen offset:3072 lds
    v_dot2c_f32_bf16 v91, v243, v243
    v_dot2c_f32_bf16 v88, s15, v244
    v_dot2c_f32_bf16 v90, v244, v244
    v_dot2c_f32_bf16 v89, s15, v245
    v_dot2c_f32_bf16 v91, v245, v245
    v_dot2c_f32_bf16 v88, s15, v246
    v_dot2c_f32_bf16 v90, v246, v246
    v_dot2c_f32_bf16 v89, s15, v247
    v_dot2c_f32_bf16 v91, v247, v247
    v_dot2c_f32_bf16 v88, s15, v248
    s_add_u32 m0, s93, 0x8000
    s_mul_i32 s98, s100, 229376
    s_add_u32 s98, s98, s89
    buffer_load_dwordx4 v12, s[60:63], s98 offen offset:0 lds
    v_dot2c_f32_bf16 v90, v248, v248
    v_dot2c_f32_bf16 v89, s15, v249
    v_dot2c_f32_bf16 v91, v249, v249
    v_dot2c_f32_bf16 v88, s15, v250
    v_dot2c_f32_bf16 v90, v250, v250
    v_dot2c_f32_bf16 v89, s15, v251
    v_dot2c_f32_bf16 v91, v251, v251
    v_dot2c_f32_bf16 v88, s15, v252
    v_dot2c_f32_bf16 v90, v252, v252
    v_dot2c_f32_bf16 v89, s15, v253
    buffer_load_dwordx4 v13, s[60:63], s98 offen offset:1024 lds
    v_dot2c_f32_bf16 v91, v253, v253
    v_dot2c_f32_bf16 v88, s15, v254
    v_dot2c_f32_bf16 v90, v254, v254
    v_dot2c_f32_bf16 v89, s15, v255
    v_dot2c_f32_bf16 v91, v255, v255
    s_nop 1
    v_add_f32 v64, v88, v89
    v_add_f32 v66, v90, v91
    v_mov_b32 v65, v64
    v_mov_b32 v67, v66
    s_nop 0
    v_permlane32_swap_b32 v64, v65
    v_permlane32_swap_b32 v66, v67
    v_add_f32 v64, v64, v65
    v_add_f32 v70, v66, v67
    v_mul_f32 v71, 0x3b000000, v64
    v_cvt_pk_bf16_f32 v28, v71, v71
    v_and_b32 v28, s14, v28
    v_sub_f32 v68, 0, v28
    s_mov_b32 s15, 0x3f80
    s_mov_b32 s16, 0x3f800000
    v_dot2_f32_bf16 v80, v128, s15, v68
    v_dot2_f32_bf16 v81, v128, s16, v68
    v_dot2_f32_bf16 v82, v129, s15, v68
    v_dot2_f32_bf16 v83, v129, s16, v68
    v_dot2_f32_bf16 v84, v130, s15, v68
    v_dot2_f32_bf16 v85, v130, s16, v68
    v_dot2_f32_bf16 v86, v131, s15, v68
    v_dot2_f32_bf16 v87, v131, s16, v68
    v_dot2_f32_bf16 v88, v132, s15, v68
    v_dot2_f32_bf16 v89, v132, s16, v68
    v_dot2_f32_bf16 v90, v133, s15, v68
    v_dot2_f32_bf16 v91, v133, s16, v68
    v_dot2_f32_bf16 v92, v134, s15, v68
    v_dot2_f32_bf16 v93, v134, s16, v68
    v_dot2_f32_bf16 v94, v135, s15, v68
    v_dot2_f32_bf16 v95, v135, s16, v68
    v_cvt_pk_bf16_f32 v128, v80, v81
    v_cvt_pk_bf16_f32 v129, v82, v83
    v_cvt_pk_bf16_f32 v130, v84, v85
    v_cvt_pk_bf16_f32 v131, v86, v87
    v_cvt_pk_bf16_f32 v132, v88, v89
    v_cvt_pk_bf16_f32 v133, v90, v91
    v_cvt_pk_bf16_f32 v134, v92, v93
    v_cvt_pk_bf16_f32 v135, v94, v95
    s_waitcnt vmcnt(10)
    s_barrier
    ds_read_b128 a[112:115], v52 offset:0
    ds_read_b128 a[116:119], v52 offset:4096
    ds_read_b128 a[120:123], v53 offset:0
    ds_read_b128 a[124:127], v53 offset:4096
    v_dot2_f32_bf16 v80, v136, s15, v68
    v_dot2_f32_bf16 v81, v136, s16, v68
    v_dot2_f32_bf16 v82, v137, s15, v68
    v_dot2_f32_bf16 v83, v137, s16, v68
    v_dot2_f32_bf16 v84, v138, s15, v68
    v_dot2_f32_bf16 v85, v138, s16, v68
    v_dot2_f32_bf16 v86, v139, s15, v68
    v_dot2_f32_bf16 v87, v139, s16, v68
    v_dot2_f32_bf16 v88, v140, s15, v68
    v_dot2_f32_bf16 v89, v140, s16, v68
    v_dot2_f32_bf16 v90, v141, s15, v68
    v_dot2_f32_bf16 v91, v141, s16, v68
    v_dot2_f32_bf16 v92, v142, s15, v68
    v_dot2_f32_bf16 v93, v142, s16, v68
    v_dot2_f32_bf16 v94, v143, s15, v68
    v_dot2_f32_bf16 v95, v143, s16, v68
    s_waitcnt lgkmcnt(2)
    v_mfma_f32_32x32x16_bf16 v[96:111], v[128:131], a[112:115], 0
    ds_read_b128 a[128:131], v54 offset:0
    v_cvt_pk_bf16_f32 v136, v80, v81
    v_cvt_pk_bf16_f32 v137, v82, v83
    buffer_load_dwordx4 v14, s[60:63], s98 offen offset:2048 lds
    v_mul_f32 v70, 0x3b000000, v70
    v_mfma_f32_32x32x16_bf16 v[112:127], v[128:131], a[116:119], 0
    ds_read_b128 a[132:135], v54 offset:4096
    v_cvt_pk_bf16_f32 v138, v84, v85
    v_cvt_pk_bf16_f32 v139, v86, v87
    buffer_load_dwordx4 v15, s[60:63], s98 offen offset:3072 lds
    v_fma_f32 v70, -v71, v71, v70
    v_max_f32 v70, 0, v70
    s_waitcnt lgkmcnt(2)
    v_mfma_f32_32x32x16_bf16 v[96:111], v[132:135], a[120:123], v[96:111]
    ds_read_b128 a[136:139], v55 offset:0
    v_cvt_pk_bf16_f32 v140, v88, v89
    v_cvt_pk_bf16_f32 v141, v90, v91
    s_add_u32 m0, s93, 0x9000
    s_add_u32 s100, s100, 1
    s_and_b32 s100, s100, 7
    buffer_load_dwordx4 v16, s[60:63], s98 offen offset:0 lds
    v_mfma_f32_32x32x16_bf16 v[112:127], v[132:135], a[124:127], v[112:127]
    ds_read_b128 a[140:143], v55 offset:4096
    v_cvt_pk_bf16_f32 v142, v92, v93
    v_cvt_pk_bf16_f32 v143, v94, v95
    buffer_load_dwordx4 v17, s[60:63], s98 offen offset:1024 lds
    v_cvt_pk_bf16_f32 v70, v70, v70
    v_and_b32 v70, s14, v70
    v_dot2_f32_bf16 v80, v144, s15, v68
    v_dot2_f32_bf16 v81, v144, s16, v68
    v_dot2_f32_bf16 v82, v145, s15, v68
    v_dot2_f32_bf16 v83, v145, s16, v68
    v_dot2_f32_bf16 v84, v146, s15, v68
    v_dot2_f32_bf16 v85, v146, s16, v68
    v_dot2_f32_bf16 v86, v147, s15, v68
    v_dot2_f32_bf16 v87, v147, s16, v68
    v_dot2_f32_bf16 v88, v148, s15, v68
    v_dot2_f32_bf16 v89, v148, s16, v68
    v_dot2_f32_bf16 v90, v149, s15, v68
    v_dot2_f32_bf16 v91, v149, s16, v68
    v_dot2_f32_bf16 v92, v150, s15, v68
    v_dot2_f32_bf16 v93, v150, s16, v68
    v_dot2_f32_bf16 v94, v151, s15, v68
    v_dot2_f32_bf16 v95, v151, s16, v68
    s_waitcnt lgkmcnt(2)
    v_mfma_f32_32x32x16_bf16 v[96:111], v[136:139], a[128:131], v[96:111]
    ds_read_b128 a[112:115], v52 offset:8192
    v_cvt_pk_bf16_f32 v144, v80, v81
    v_cvt_pk_bf16_f32 v145, v82, v83
    buffer_load_dwordx4 v18, s[60:63], s98 offen offset:2048 lds
    v_add_f32 v70, 0x3727c5ac, v70
    v_mfma_f32_32x32x16_bf16 v[112:127], v[136:139], a[132:135], v[112:127]
    ds_read_b128 a[116:119], v52 offset:12288
    v_cvt_pk_bf16_f32 v146, v84, v85
    v_cvt_pk_bf16_f32 v147, v86, v87
    global_load_dword a212, v69, s[18:19]
    v_cvt_pk_bf16_f32 v70, v70, v70
    v_and_b32 v70, s14, v70
    s_waitcnt lgkmcnt(2)
    v_mfma_f32_32x32x16_bf16 v[96:111], v[140:143], a[136:139], v[96:111]
    ds_read_b128 a[120:123], v53 offset:8192
    v_cvt_pk_bf16_f32 v148, v88, v89
    v_cvt_pk_bf16_f32 v149, v90, v91
    v_sqrt_f32 v70, v70
    v_lshl_add_u32 v71, v27, 2, s13
    v_mfma_f32_32x32x16_bf16 v[112:127], v[140:143], a[140:143], v[112:127]
    ds_read_b128 a[124:127], v53 offset:12288
    v_cvt_pk_bf16_f32 v150, v92, v93
    v_cvt_pk_bf16_f32 v151, v94, v95
    v_cvt_pk_bf16_f32 v70, v70, v70
    v_and_b32 v70, s14, v70
    v_rcp_f32 v29, v70
    v_dot2_f32_bf16 v80, v152, s15, v68
    v_dot2_f32_bf16 v81, v152, s16, v68
    v_dot2_f32_bf16 v82, v153, s15, v68
    v_dot2_f32_bf16 v83, v153, s16, v68
    v_dot2_f32_bf16 v84, v154, s15, v68
    v_dot2_f32_bf16 v85, v154, s16, v68
    v_dot2_f32_bf16 v86, v155, s15, v68
    v_dot2_f32_bf16 v87, v155, s16, v68
    v_dot2_f32_bf16 v88, v156, s15, v68
    v_dot2_f32_bf16 v89, v156, s16, v68
    v_dot2_f32_bf16 v90, v157, s15, v68
    v_dot2_f32_bf16 v91, v157, s16, v68
    v_dot2_f32_bf16 v92, v158, s15, v68
    v_dot2_f32_bf16 v93, v158, s16, v68
    v_dot2_f32_bf16 v94, v159, s15, v68
    v_dot2_f32_bf16 v95, v159, s16, v68
    s_waitcnt lgkmcnt(2)
    v_mfma_f32_32x32x16_bf16 v[96:111], v[144:147], a[112:115], v[96:111]
    ds_read_b128 a[128:131], v54 offset:8192
    v_cvt_pk_bf16_f32 v152, v80, v81
    v_cvt_pk_bf16_f32 v153, v82, v83
    v_mul_f32 v30, v70, v70
    ds_write_b32 v71, v29 offset:40192
    v_mfma_f32_32x32x16_bf16 v[112:127], v[144:147], a[116:119], v[112:127]
    ds_read_b128 a[132:135], v54 offset:12288
    v_cvt_pk_bf16_f32 v154, v84, v85
    v_cvt_pk_bf16_f32 v155, v86, v87
    ds_write_b32 v71, v30 offset:40576
    v_lshlrev_b32 v74, 16, v74
    v_mul_f32 v64, 0x3fb8aa3b, v74
    s_waitcnt lgkmcnt(4)
    v_mfma_f32_32x32x16_bf16 v[96:111], v[148:151], a[120:123], v[96:111]
    ds_read_b128 a[136:139], v55 offset:8192
    v_cvt_pk_bf16_f32 v156, v88, v89
    v_cvt_pk_bf16_f32 v157, v90, v91
    v_exp_f32 v64, v64
    v_lshlrev_b32 v72, 16, v72
    v_mfma_f32_32x32x16_bf16 v[112:127], v[148:151], a[124:127], v[112:127]
    ds_read_b128 a[140:143], v55 offset:12288
    v_cvt_pk_bf16_f32 v158, v92, v93
    v_cvt_pk_bf16_f32 v159, v94, v95
    v_lshlrev_b32 v73, 16, v73
    v_cvt_pk_bf16_f32 v64, v64, v64
    v_and_b32 v64, s14, v64
    v_dot2_f32_bf16 v80, v160, s15, v68
    v_dot2_f32_bf16 v81, v160, s16, v68
    v_dot2_f32_bf16 v82, v161, s15, v68
    v_dot2_f32_bf16 v83, v161, s16, v68
    v_dot2_f32_bf16 v84, v162, s15, v68
    v_dot2_f32_bf16 v85, v162, s16, v68
    v_dot2_f32_bf16 v86, v163, s15, v68
    v_dot2_f32_bf16 v87, v163, s16, v68
    v_dot2_f32_bf16 v88, v164, s15, v68
    v_dot2_f32_bf16 v89, v164, s16, v68
    v_dot2_f32_bf16 v90, v165, s15, v68
    v_dot2_f32_bf16 v91, v165, s16, v68
    v_dot2_f32_bf16 v92, v166, s15, v68
    v_dot2_f32_bf16 v93, v166, s16, v68
    v_dot2_f32_bf16 v94, v167, s15, v68
    v_dot2_f32_bf16 v95, v167, s16, v68
    s_waitcnt lgkmcnt(3)
    v_mfma_f32_32x32x16_bf16 v[96:111], v[152:155], a[128:131], v[96:111]
    ds_read_b128 a[112:115], v52 offset:16384
    v_cvt_pk_bf16_f32 v160, v80, v81
    v_cvt_pk_bf16_f32 v161, v82, v83
    v_mul_f32 v65, v64, v72
    v_mul_f32 v66, v64, v73
    v_mfma_f32_32x32x16_bf16 v[112:127], v[152:155], a[132:135], v[112:127]
    ds_read_b128 a[116:119], v52 offset:20480
    v_cvt_pk_bf16_f32 v162, v84, v85
    v_cvt_pk_bf16_f32 v163, v86, v87
    v_mul_f32 v65, 0x3fb8aa3b, v65
    v_exp_f32 v65, v65
    v_mul_f32 v66, 0.15915494, v66
    s_waitcnt lgkmcnt(2)
    v_mfma_f32_32x32x16_bf16 v[96:111], v[156:159], a[136:139], v[96:111]
    ds_read_b128 a[120:123], v53 offset:16384
    v_cvt_pk_bf16_f32 v164, v88, v89
    v_cvt_pk_bf16_f32 v165, v90, v91
    v_rndne_f32 v67, v66
    v_sub_f32 v66, v66, v67
    v_mfma_f32_32x32x16_bf16 v[112:127], v[156:159], a[140:143], v[112:127]
    ds_read_b128 a[124:127], v53 offset:20480
    v_cvt_pk_bf16_f32 v166, v92, v93
    v_cvt_pk_bf16_f32 v167, v94, v95
    v_cos_f32 v67, v66
    v_sin_f32 v66, v66
    v_mul_f32 v32, v65, v67
    v_dot2_f32_bf16 v80, v168, s15, v68
    v_dot2_f32_bf16 v81, v168, s16, v68
    v_dot2_f32_bf16 v82, v169, s15, v68
    v_dot2_f32_bf16 v83, v169, s16, v68
    v_dot2_f32_bf16 v84, v170, s15, v68
    v_dot2_f32_bf16 v85, v170, s16, v68
    v_dot2_f32_bf16 v86, v171, s15, v68
    v_dot2_f32_bf16 v87, v171, s16, v68
    v_dot2_f32_bf16 v88, v172, s15, v68
    v_dot2_f32_bf16 v89, v172, s16, v68
    v_dot2_f32_bf16 v90, v173, s15, v68
    v_dot2_f32_bf16 v91, v173, s16, v68
    v_dot2_f32_bf16 v92, v174, s15, v68
    v_dot2_f32_bf16 v93, v174, s16, v68
    v_dot2_f32_bf16 v94, v175, s15, v68
    v_dot2_f32_bf16 v95, v175, s16, v68
    s_waitcnt lgkmcnt(2)
    v_mfma_f32_32x32x16_bf16 v[96:111], v[160:163], a[112:115], v[96:111]
    ds_read_b128 a[128:131], v54 offset:16384
    v_cvt_pk_bf16_f32 v168, v80, v81
    v_cvt_pk_bf16_f32 v169, v82, v83
    v_mul_f32 v33, v65, v66
    v_sub_f32 v34, 0, v33
    v_mfma_f32_32x32x16_bf16 v[112:127], v[160:163], a[116:119], v[112:127]
    ds_read_b128 a[132:135], v54 offset:20480
    v_cvt_pk_bf16_f32 v170, v84, v85
    v_cvt_pk_bf16_f32 v171, v86, v87
    v_mul_f32 v64, v72, v72
    v_fmac_f32 v64, v73, v73
    v_rcp_f32 v64, v64
    s_waitcnt lgkmcnt(2)
    v_mfma_f32_32x32x16_bf16 v[96:111], v[164:167], a[120:123], v[96:111]
    ds_read_b128 a[136:139], v55 offset:16384
    v_cvt_pk_bf16_f32 v172, v88, v89
    v_cvt_pk_bf16_f32 v173, v90, v91
    v_subrev_f32 v65, 1.0, v32
    v_add_f32 v64, v64, v64
    v_mfma_f32_32x32x16_bf16 v[112:127], v[164:167], a[124:127], v[112:127]
    ds_read_b128 a[140:143], v55 offset:20480
    v_cvt_pk_bf16_f32 v174, v92, v93
    v_cvt_pk_bf16_f32 v175, v94, v95
    v_mul_f32 v66, v65, v72
    v_fmac_f32 v66, v33, v73
    v_mul_f32 v67, v33, v72
    v_dot2_f32_bf16 v80, v176, s15, v68
    v_dot2_f32_bf16 v81, v176, s16, v68
    v_dot2_f32_bf16 v82, v177, s15, v68
    v_dot2_f32_bf16 v83, v177, s16, v68
    v_dot2_f32_bf16 v84, v178, s15, v68
    v_dot2_f32_bf16 v85, v178, s16, v68
    v_dot2_f32_bf16 v86, v179, s15, v68
    v_dot2_f32_bf16 v87, v179, s16, v68
    v_dot2_f32_bf16 v88, v180, s15, v68
    v_dot2_f32_bf16 v89, v180, s16, v68
    v_dot2_f32_bf16 v90, v181, s15, v68
    v_dot2_f32_bf16 v91, v181, s16, v68
    v_dot2_f32_bf16 v92, v182, s15, v68
    v_dot2_f32_bf16 v93, v182, s16, v68
    v_dot2_f32_bf16 v94, v183, s15, v68
    v_dot2_f32_bf16 v95, v183, s16, v68
    s_waitcnt lgkmcnt(2)
    v_mfma_f32_32x32x16_bf16 v[96:111], v[168:171], a[128:131], v[96:111]
    ds_read_b128 a[112:115], v52 offset:24576
    v_cvt_pk_bf16_f32 v176, v80, v81
    v_cvt_pk_bf16_f32 v177, v82, v83
    v_fma_f32 v67, -v65, v73, v67
    v_mul_f32 v36, v66, v64
    v_mfma_f32_32x32x16_bf16 v[112:127], v[168:171], a[132:135], v[112:127]
    ds_read_b128 a[116:119], v52 offset:28672
    v_cvt_pk_bf16_f32 v178, v84, v85
    v_cvt_pk_bf16_f32 v179, v86, v87
    v_mul_f32 v37, v67, v64
    v_mul_f32 v64, v33, v33
    v_add_f32 v65, v32, v32
    s_waitcnt lgkmcnt(2)
    v_mfma_f32_32x32x16_bf16 v[96:111], v[172:175], a[136:139], v[96:111]
    ds_read_b128 a[120:123], v53 offset:24576
    v_cvt_pk_bf16_f32 v180, v88, v89
    v_cvt_pk_bf16_f32 v181, v90, v91
    v_fma_f32 v48, v32, v32, -v64
    v_mul_f32 v49, v65, v33
    v_mfma_f32_32x32x16_bf16 v[112:127], v[172:175], a[140:143], v[112:127]
    ds_read_b128 a[124:127], v53 offset:28672
    v_cvt_pk_bf16_f32 v182, v92, v93
    v_cvt_pk_bf16_f32 v183, v94, v95
    v_mul_f32 v64, v49, v49
    v_add_f32 v65, v48, v48
    v_fma_f32 v38, v48, v48, -v64
    v_dot2_f32_bf16 v80, v184, s15, v68
    v_dot2_f32_bf16 v81, v184, s16, v68
    v_dot2_f32_bf16 v82, v185, s15, v68
    v_dot2_f32_bf16 v83, v185, s16, v68
    v_dot2_f32_bf16 v84, v186, s15, v68
    v_dot2_f32_bf16 v85, v186, s16, v68
    v_dot2_f32_bf16 v86, v187, s15, v68
    v_dot2_f32_bf16 v87, v187, s16, v68
    v_dot2_f32_bf16 v88, v188, s15, v68
    v_dot2_f32_bf16 v89, v188, s16, v68
    v_dot2_f32_bf16 v90, v189, s15, v68
    v_dot2_f32_bf16 v91, v189, s16, v68
    v_dot2_f32_bf16 v92, v190, s15, v68
    v_dot2_f32_bf16 v93, v190, s16, v68
    v_dot2_f32_bf16 v94, v191, s15, v68
    v_dot2_f32_bf16 v95, v191, s16, v68
    s_waitcnt lgkmcnt(2)
    v_mfma_f32_32x32x16_bf16 v[96:111], v[176:179], a[112:115], v[96:111]
    ds_read_b128 a[128:131], v54 offset:24576
    v_cvt_pk_bf16_f32 v184, v80, v81
    v_cvt_pk_bf16_f32 v185, v82, v83
    buffer_store_dwordx4 a[208:211], v19, s[84:87], 0 offen sc1
    v_mul_f32 v39, v65, v49
    v_mfma_f32_32x32x16_bf16 v[112:127], v[176:179], a[116:119], v[112:127]
    ds_read_b128 a[132:135], v54 offset:28672
    v_cvt_pk_bf16_f32 v186, v84, v85
    v_cvt_pk_bf16_f32 v187, v86, v87
    v_mul_f32 v64, v39, v39
    v_add_f32 v65, v38, v38
    v_fma_f32 v38, v38, v38, -v64
    s_waitcnt lgkmcnt(2)
    v_mfma_f32_32x32x16_bf16 v[96:111], v[180:183], a[120:123], v[96:111]
    ds_read_b128 a[136:139], v55 offset:24576
    v_cvt_pk_bf16_f32 v188, v88, v89
    v_cvt_pk_bf16_f32 v189, v90, v91
    v_mul_f32 v39, v65, v39
    v_mul_f32 v64, v39, v39
    v_mfma_f32_32x32x16_bf16 v[112:127], v[180:183], a[124:127], v[112:127]
    ds_read_b128 a[140:143], v55 offset:28672
    v_cvt_pk_bf16_f32 v190, v92, v93
    v_cvt_pk_bf16_f32 v191, v94, v95
    v_add_f32 v65, v38, v38
    v_fma_f32 v38, v38, v38, -v64
    v_mul_f32 v39, v65, v39
    v_dot2_f32_bf16 v80, v192, s15, v68
    v_dot2_f32_bf16 v81, v192, s16, v68
    v_dot2_f32_bf16 v82, v193, s15, v68
    v_dot2_f32_bf16 v83, v193, s16, v68
    v_dot2_f32_bf16 v84, v194, s15, v68
    v_dot2_f32_bf16 v85, v194, s16, v68
    v_dot2_f32_bf16 v86, v195, s15, v68
    v_dot2_f32_bf16 v87, v195, s16, v68
    v_dot2_f32_bf16 v88, v196, s15, v68
    v_dot2_f32_bf16 v89, v196, s16, v68
    v_dot2_f32_bf16 v90, v197, s15, v68
    v_dot2_f32_bf16 v91, v197, s16, v68
    v_dot2_f32_bf16 v92, v198, s15, v68
    v_dot2_f32_bf16 v93, v198, s16, v68
    v_dot2_f32_bf16 v94, v199, s15, v68
    v_dot2_f32_bf16 v95, v199, s16, v68
    s_waitcnt lgkmcnt(2)
    v_mfma_f32_32x32x16_bf16 v[96:111], v[184:187], a[128:131], v[96:111]
    s_waitcnt vmcnt(9)
    s_barrier
    ds_read_b128 a[112:115], v20 offset:0
    v_cvt_pk_bf16_f32 v192, v80, v81
    v_cvt_pk_bf16_f32 v193, v82, v83
    v_mfma_f32_32x32x16_bf16 v[112:127], v[184:187], a[132:135], v[112:127]
    ds_read_b128 a[116:119], v20 offset:4096
    v_cvt_pk_bf16_f32 v194, v84, v85
    v_cvt_pk_bf16_f32 v195, v86, v87
    v_mul_f32 v64, v39, v39
    v_add_f32 v65, v38, v38
    v_fma_f32 v40, v38, v38, -v64
    s_waitcnt lgkmcnt(2)
    v_mfma_f32_32x32x16_bf16 v[96:111], v[188:191], a[136:139], v[96:111]
    ds_read_b128 a[120:123], v21 offset:0
    v_cvt_pk_bf16_f32 v196, v88, v89
    v_cvt_pk_bf16_f32 v197, v90, v91
    v_mov_b32 v51, 0
    global_load_dword v50, v51, s[44:45] sc1
    v_mfma_f32_32x32x16_bf16 v[112:127], v[188:191], a[140:143], v[112:127]
    ds_read_b128 a[124:127], v21 offset:4096
    v_cvt_pk_bf16_f32 v198, v92, v93
    v_cvt_pk_bf16_f32 v199, v94, v95
    v_mul_f32 v41, v65, v39
    v_mul_f32 v64, v41, v41
    v_add_f32 v65, v40, v40
    v_dot2_f32_bf16 v80, v200, s15, v68
    v_dot2_f32_bf16 v81, v200, s16, v68
    v_dot2_f32_bf16 v82, v201, s15, v68
    v_dot2_f32_bf16 v83, v201, s16, v68
    v_dot2_f32_bf16 v84, v202, s15, v68
    v_dot2_f32_bf16 v85, v202, s16, v68
    v_dot2_f32_bf16 v86, v203, s15, v68
    v_dot2_f32_bf16 v87, v203, s16, v68
    v_dot2_f32_bf16 v88, v204, s15, v68
    v_dot2_f32_bf16 v89, v204, s16, v68
    v_dot2_f32_bf16 v90, v205, s15, v68
    v_dot2_f32_bf16 v91, v205, s16, v68
    v_dot2_f32_bf16 v92, v206, s15, v68
    v_dot2_f32_bf16 v93, v206, s16, v68
    v_dot2_f32_bf16 v94, v207, s15, v68
    v_dot2_f32_bf16 v95, v207, s16, v68
    s_waitcnt lgkmcnt(2)
    v_mfma_f32_32x32x16_bf16 v[96:111], v[192:195], a[112:115], v[96:111]
    ds_read_b128 a[128:131], v22 offset:0
    v_cvt_pk_bf16_f32 v200, v80, v81
    v_cvt_pk_bf16_f32 v201, v82, v83
    v_fma_f32 v78, v40, v40, -v64
    v_mul_f32 v79, v65, v41
    v_mfma_f32_32x32x16_bf16 v[112:127], v[192:195], a[116:119], v[112:127]
    ds_read_b128 a[132:135], v22 offset:4096
    v_cvt_pk_bf16_f32 v202, v84, v85
    v_cvt_pk_bf16_f32 v203, v86, v87
    v_mul_f32 v64, v79, v79
    v_add_f32 v65, v78, v78
    v_fma_f32 v42, v78, v78, -v64
    s_waitcnt lgkmcnt(2)
    v_mfma_f32_32x32x16_bf16 v[96:111], v[196:199], a[120:123], v[96:111]
    ds_read_b128 a[136:139], v23 offset:0
    v_cvt_pk_bf16_f32 v204, v88, v89
    v_cvt_pk_bf16_f32 v205, v90, v91
    v_mul_f32 v43, v65, v79
    v_mul_f32 v64, v43, v43
    v_mfma_f32_32x32x16_bf16 v[112:127], v[196:199], a[124:127], v[112:127]
    ds_read_b128 a[140:143], v23 offset:4096
    v_cvt_pk_bf16_f32 v206, v92, v93
    v_cvt_pk_bf16_f32 v207, v94, v95
    v_add_f32 v65, v42, v42
    v_fma_f32 v44, v42, v42, -v64
    v_mul_f32 v45, v65, v43
    v_dot2_f32_bf16 v80, v208, s15, v68
    v_dot2_f32_bf16 v81, v208, s16, v68
    v_dot2_f32_bf16 v82, v209, s15, v68
    v_dot2_f32_bf16 v83, v209, s16, v68
    v_dot2_f32_bf16 v84, v210, s15, v68
    v_dot2_f32_bf16 v85, v210, s16, v68
    v_dot2_f32_bf16 v86, v211, s15, v68
    v_dot2_f32_bf16 v87, v211, s16, v68
    v_dot2_f32_bf16 v88, v212, s15, v68
    v_dot2_f32_bf16 v89, v212, s16, v68
    v_dot2_f32_bf16 v90, v213, s15, v68
    v_dot2_f32_bf16 v91, v213, s16, v68
    v_dot2_f32_bf16 v92, v214, s15, v68
    v_dot2_f32_bf16 v93, v214, s16, v68
    v_dot2_f32_bf16 v94, v215, s15, v68
    v_dot2_f32_bf16 v95, v215, s16, v68
    s_waitcnt lgkmcnt(2)
    v_mfma_f32_32x32x16_bf16 v[96:111], v[200:203], a[128:131], v[96:111]
    ds_read_b128 a[112:115], v20 offset:8192
    v_cvt_pk_bf16_f32 v208, v80, v81
    v_cvt_pk_bf16_f32 v209, v82, v83
    v_mul_f32 v64, v45, v45
    v_add_f32 v65, v44, v44
    v_mfma_f32_32x32x16_bf16 v[112:127], v[200:203], a[132:135], v[112:127]
    ds_read_b128 a[116:119], v20 offset:12288
    v_cvt_pk_bf16_f32 v210, v84, v85
    v_cvt_pk_bf16_f32 v211, v86, v87
    v_fma_f32 v44, v44, v44, -v64
    v_mul_f32 v45, v65, v45
    v_mul_f32 v64, v45, v45
    s_waitcnt lgkmcnt(2)
    v_mfma_f32_32x32x16_bf16 v[96:111], v[204:207], a[136:139], v[96:111]
    ds_read_b128 a[120:123], v21 offset:8192
    v_cvt_pk_bf16_f32 v212, v88, v89
    v_cvt_pk_bf16_f32 v213, v90, v91
    v_add_f32 v65, v44, v44
    v_fma_f32 v44, v44, v44, -v64
    v_mfma_f32_32x32x16_bf16 v[112:127], v[204:207], a[140:143], v[112:127]
    ds_read_b128 a[124:127], v21 offset:12288
    v_cvt_pk_bf16_f32 v214, v92, v93
    v_cvt_pk_bf16_f32 v215, v94, v95
    v_mul_f32 v45, v65, v45
    s_bitcmp1_b32 s3, 0
    s_cselect_b64 s[30:31], -1, 0
    v_dot2_f32_bf16 v80, v216, s15, v68
    v_dot2_f32_bf16 v81, v216, s16, v68
    v_dot2_f32_bf16 v82, v217, s15, v68
    v_dot2_f32_bf16 v83, v217, s16, v68
    v_dot2_f32_bf16 v84, v218, s15, v68
    v_dot2_f32_bf16 v85, v218, s16, v68
    v_dot2_f32_bf16 v86, v219, s15, v68
    v_dot2_f32_bf16 v87, v219, s16, v68
    v_dot2_f32_bf16 v88, v220, s15, v68
    v_dot2_f32_bf16 v89, v220, s16, v68
    v_dot2_f32_bf16 v90, v221, s15, v68
    v_dot2_f32_bf16 v91, v221, s16, v68
    v_dot2_f32_bf16 v92, v222, s15, v68
    v_dot2_f32_bf16 v93, v222, s16, v68
    v_dot2_f32_bf16 v94, v223, s15, v68
    v_dot2_f32_bf16 v95, v223, s16, v68
    s_waitcnt lgkmcnt(2)
    v_mfma_f32_32x32x16_bf16 v[96:111], v[208:211], a[112:115], v[96:111]
    ds_read_b128 a[128:131], v22 offset:8192
    v_cvt_pk_bf16_f32 v216, v80, v81
    v_cvt_pk_bf16_f32 v217, v82, v83
    s_add_u32 m0, s93, 0x10000
    s_mul_i32 s98, s100, 229376
    s_add_u32 s98, s98, s89
    buffer_load_dwordx4 v12, s[60:63], s98 offen offset:0 lds
    v_mfma_f32_32x32x16_bf16 v[112:127], v[208:211], a[116:119], v[112:127]
    ds_read_b128 a[132:135], v22 offset:12288
    v_cvt_pk_bf16_f32 v218, v84, v85
    v_cvt_pk_bf16_f32 v219, v86, v87
    s_bitcmp1_b32 s3, 1
    s_cselect_b64 s[42:43], -1, 0
    v_cndmask_b32 v46, 1.0, v38, s[96:97]
    s_waitcnt lgkmcnt(2)
    v_mfma_f32_32x32x16_bf16 v[96:111], v[212:215], a[120:123], v[96:111]
    ds_read_b128 a[136:139], v23 offset:8192
    v_cvt_pk_bf16_f32 v220, v88, v89
    v_cvt_pk_bf16_f32 v221, v90, v91
    buffer_load_dwordx4 v13, s[60:63], s98 offen offset:1024 lds
    v_cndmask_b32 v47, 0, v39, s[96:97]
    v_mfma_f32_32x32x16_bf16 v[112:127], v[212:215], a[124:127], v[112:127]
    ds_read_b128 a[140:143], v23 offset:12288
    v_cvt_pk_bf16_f32 v222, v92, v93
    v_cvt_pk_bf16_f32 v223, v94, v95
    v_cndmask_b32 v66, 1.0, v40, s[30:31]
    v_cndmask_b32 v67, 0, v41, s[30:31]
    v_mul_f32 v64, v46, v66
    v_dot2_f32_bf16 v80, v224, s15, v68
    v_dot2_f32_bf16 v81, v224, s16, v68
    v_dot2_f32_bf16 v82, v225, s15, v68
    v_dot2_f32_bf16 v83, v225, s16, v68
    v_dot2_f32_bf16 v84, v226, s15, v68
    v_dot2_f32_bf16 v85, v226, s16, v68
    v_dot2_f32_bf16 v86, v227, s15, v68
    v_dot2_f32_bf16 v87, v227, s16, v68
    v_dot2_f32_bf16 v88, v228, s15, v68
    v_dot2_f32_bf16 v89, v228, s16, v68
    v_dot2_f32_bf16 v90, v229, s15, v68
    v_dot2_f32_bf16 v91, v229, s16, v68
    v_dot2_f32_bf16 v92, v230, s15, v68
    v_dot2_f32_bf16 v93, v230, s16, v68
    v_dot2_f32_bf16 v94, v231, s15, v68
    v_dot2_f32_bf16 v95, v231, s16, v68
    s_waitcnt lgkmcnt(2)
    v_mfma_f32_32x32x16_bf16 v[96:111], v[216:219], a[128:131], v[96:111]
    ds_read_b128 a[112:115], v20 offset:16384
    v_cvt_pk_bf16_f32 v224, v80, v81
    v_cvt_pk_bf16_f32 v225, v82, v83
    buffer_load_dwordx4 v14, s[60:63], s98 offen offset:2048 lds
    v_mul_f32 v65, v46, v67
    v_mfma_f32_32x32x16_bf16 v[112:127], v[216:219], a[132:135], v[112:127]
    ds_read_b128 a[116:119], v20 offset:20480
    v_cvt_pk_bf16_f32 v226, v84, v85
    v_cvt_pk_bf16_f32 v227, v86, v87
    v_fma_f32 v64, -v47, v67, v64
    v_fma_f32 v47, v47, v66, v65
    v_mov_b32 v46, v64
    s_waitcnt lgkmcnt(2)
    v_mfma_f32_32x32x16_bf16 v[96:111], v[220:223], a[136:139], v[96:111]
    ds_read_b128 a[120:123], v21 offset:16384
    v_cvt_pk_bf16_f32 v228, v88, v89
    v_cvt_pk_bf16_f32 v229, v90, v91
    buffer_load_dwordx4 v15, s[60:63], s98 offen offset:3072 lds
    v_cndmask_b32 v66, 1.0, v78, s[42:43]
    v_mfma_f32_32x32x16_bf16 v[112:127], v[220:223], a[140:143], v[112:127]
    ds_read_b128 a[124:127], v21 offset:20480
    v_cvt_pk_bf16_f32 v230, v92, v93
    v_cvt_pk_bf16_f32 v231, v94, v95
    v_cndmask_b32 v67, 0, v79, s[42:43]
    v_mul_f32 v64, v46, v66
    v_mul_f32 v65, v46, v67
    v_dot2_f32_bf16 v80, v232, s15, v68
    v_dot2_f32_bf16 v81, v232, s16, v68
    v_dot2_f32_bf16 v82, v233, s15, v68
    v_dot2_f32_bf16 v83, v233, s16, v68
    v_dot2_f32_bf16 v84, v234, s15, v68
    v_dot2_f32_bf16 v85, v234, s16, v68
    v_dot2_f32_bf16 v86, v235, s15, v68
    v_dot2_f32_bf16 v87, v235, s16, v68
    v_dot2_f32_bf16 v88, v236, s15, v68
    v_dot2_f32_bf16 v89, v236, s16, v68
    v_dot2_f32_bf16 v90, v237, s15, v68
    v_dot2_f32_bf16 v91, v237, s16, v68
    v_dot2_f32_bf16 v92, v238, s15, v68
    v_dot2_f32_bf16 v93, v238, s16, v68
    v_dot2_f32_bf16 v94, v239, s15, v68
    v_dot2_f32_bf16 v95, v239, s16, v68
    s_waitcnt lgkmcnt(2)
    v_mfma_f32_32x32x16_bf16 v[96:111], v[224:227], a[112:115], v[96:111]
    ds_read_b128 a[128:131], v22 offset:16384
    v_cvt_pk_bf16_f32 v232, v80, v81
    v_cvt_pk_bf16_f32 v233, v82, v83
    s_add_u32 m0, s93, 0x11000
    s_add_u32 s100, s100, 1
    s_and_b32 s100, s100, 7
    buffer_load_dwordx4 v16, s[60:63], s98 offen offset:0 lds
    v_mfma_f32_32x32x16_bf16 v[112:127], v[224:227], a[116:119], v[112:127]
    ds_read_b128 a[132:135], v22 offset:20480
    v_cvt_pk_bf16_f32 v234, v84, v85
    v_cvt_pk_bf16_f32 v235, v86, v87
    v_fma_f32 v64, -v47, v67, v64
    v_fma_f32 v47, v47, v66, v65
    v_mov_b32 v46, v64
    s_waitcnt lgkmcnt(2)
    v_mfma_f32_32x32x16_bf16 v[96:111], v[228:231], a[120:123], v[96:111]
    ds_read_b128 a[136:139], v23 offset:16384
    v_cvt_pk_bf16_f32 v236, v88, v89
    v_cvt_pk_bf16_f32 v237, v90, v91
    buffer_load_dwordx4 v17, s[60:63], s98 offen offset:1024 lds
    v_mfma_f32_32x32x16_bf16 v[112:127], v[228:231], a[124:127], v[112:127]
    ds_read_b128 a[140:143], v23 offset:20480
    v_cvt_pk_bf16_f32 v238, v92, v93
    v_cvt_pk_bf16_f32 v239, v94, v95
    v_dot2_f32_bf16 v80, v240, s15, v68
    v_dot2_f32_bf16 v81, v240, s16, v68
    v_dot2_f32_bf16 v82, v241, s15, v68
    v_dot2_f32_bf16 v83, v241, s16, v68
    v_dot2_f32_bf16 v84, v242, s15, v68
    v_dot2_f32_bf16 v85, v242, s16, v68
    v_dot2_f32_bf16 v86, v243, s15, v68
    v_dot2_f32_bf16 v87, v243, s16, v68
    v_dot2_f32_bf16 v88, v244, s15, v68
    v_dot2_f32_bf16 v89, v244, s16, v68
    v_dot2_f32_bf16 v90, v245, s15, v68
    v_dot2_f32_bf16 v91, v245, s16, v68
    v_dot2_f32_bf16 v92, v246, s15, v68
    v_dot2_f32_bf16 v93, v246, s16, v68
    v_dot2_f32_bf16 v94, v247, s15, v68
    v_dot2_f32_bf16 v95, v247, s16, v68
    s_waitcnt lgkmcnt(2)
    v_mfma_f32_32x32x16_bf16 v[96:111], v[232:235], a[128:131], v[96:111]
    ds_read_b128 a[112:115], v20 offset:24576
    v_cvt_pk_bf16_f32 v240, v80, v81
    v_cvt_pk_bf16_f32 v241, v82, v83
    buffer_load_dwordx4 v18, s[60:63], s98 offen offset:2048 lds
    v_mfma_f32_32x32x16_bf16 v[112:127], v[232:235], a[132:135], v[112:127]
    ds_read_b128 a[116:119], v20 offset:28672
    v_cvt_pk_bf16_f32 v242, v84, v85
    v_cvt_pk_bf16_f32 v243, v86, v87
    s_waitcnt lgkmcnt(2)
    v_mfma_f32_32x32x16_bf16 v[96:111], v[236:239], a[136:139], v[96:111]
    ds_read_b128 a[120:123], v21 offset:24576
    v_cvt_pk_bf16_f32 v244, v88, v89
    v_cvt_pk_bf16_f32 v245, v90, v91
    s_add_u32 m0, s93, 0x18000
    s_mul_i32 s98, s100, 229376
    s_add_u32 s98, s98, s89
    buffer_load_dwordx4 v12, s[60:63], s98 offen offset:0 lds
    v_mfma_f32_32x32x16_bf16 v[112:127], v[236:239], a[140:143], v[112:127]
    ds_read_b128 a[124:127], v21 offset:28672
    v_cvt_pk_bf16_f32 v246, v92, v93
    v_cvt_pk_bf16_f32 v247, v94, v95
    v_dot2_f32_bf16 v80, v248, s15, v68
    v_dot2_f32_bf16 v81, v248, s16, v68
    v_dot2_f32_bf16 v82, v249, s15, v68
    v_dot2_f32_bf16 v83, v249, s16, v68
    v_dot2_f32_bf16 v84, v250, s15, v68
    v_dot2_f32_bf16 v85, v250, s16, v68
    v_dot2_f32_bf16 v86, v251, s15, v68
    v_dot2_f32_bf16 v87, v251, s16, v68
    v_dot2_f32_bf16 v88, v252, s15, v68
    v_dot2_f32_bf16 v89, v252, s16, v68
    v_dot2_f32_bf16 v90, v253, s15, v68
    v_dot2_f32_bf16 v91, v253, s16, v68
    v_dot2_f32_bf16 v92, v254, s15, v68
    v_dot2_f32_bf16 v93, v254, s16, v68
    v_dot2_f32_bf16 v94, v255, s15, v68
    v_dot2_f32_bf16 v95, v255, s16, v68
    s_waitcnt lgkmcnt(2)
    v_mfma_f32_32x32x16_bf16 v[96:111], v[240:243], a[112:115], v[96:111]
    ds_read_b128 a[128:131], v22 offset:24576
    v_cvt_pk_bf16_f32 v248, v80, v81
    v_cvt_pk_bf16_f32 v249, v82, v83
    buffer_load_dwordx4 v13, s[60:63], s98 offen offset:1024 lds
    v_mfma_f32_32x32x16_bf16 v[112:127], v[240:243], a[116:119], v[112:127]
    ds_read_b128 a[132:135], v22 offset:28672
    v_cvt_pk_bf16_f32 v250, v84, v85
    v_cvt_pk_bf16_f32 v251, v86, v87
    s_waitcnt lgkmcnt(2)
    v_mfma_f32_32x32x16_bf16 v[96:111], v[244:247], a[120:123], v[96:111]
    ds_read_b128 a[136:139], v23 offset:24576
    v_cvt_pk_bf16_f32 v252, v88, v89
    v_cvt_pk_bf16_f32 v253, v90, v91
    buffer_load_dwordx4 v14, s[60:63], s98 offen offset:2048 lds
    v_mfma_f32_32x32x16_bf16 v[112:127], v[244:247], a[124:127], v[112:127]
    ds_read_b128 a[140:143], v23 offset:28672
    v_cvt_pk_bf16_f32 v254, v92, v93
    v_cvt_pk_bf16_f32 v255, v94, v95
    s_waitcnt lgkmcnt(2)
    v_mfma_f32_32x32x16_bf16 v[96:111], v[248:251], a[128:131], v[96:111]
    buffer_load_dwordx4 v15, s[60:63], s98 offen offset:3072 lds
    v_mfma_f32_32x32x16_bf16 v[112:127], v[248:251], a[132:135], v[112:127]
    s_waitcnt lgkmcnt(0)
    v_mfma_f32_32x32x16_bf16 v[96:111], v[252:255], a[136:139], v[96:111]
    s_add_u32 m0, s93, 0x19000
    s_add_u32 s100, s100, 1
    s_and_b32 s100, s100, 7
    buffer_load_dwordx4 v16, s[60:63], s98 offen offset:0 lds
    v_mfma_f32_32x32x16_bf16 v[112:127], v[252:255], a[140:143], v[112:127]
    v_lshl_add_u32 v71, v2, 6, s13
    ds_read_b128 v[80:83], v71 offset:40192
    ds_read_b128 v[84:87], v71 offset:40208
    ds_read_b128 v[88:91], v71 offset:40224
    ds_read_b128 v[92:95], v71 offset:40240
    v_xor_b32 v4, s21, v8
    v_xor_b32 v8, s92, v8
    v_xor_b32 v5, s21, v9
    v_xor_b32 v9, s92, v9
    v_xor_b32 v6, s21, v10
    v_xor_b32 v10, s92, v10
    v_xor_b32 v7, s21, v11
    v_xor_b32 v11, s92, v11
    s_waitcnt vmcnt(12)
    v_cmp_eq_u32 vcc, 0, v50
    s_nop 0
    s_cbranch_vccnz L_slow_n
L_back_n:
    v_readfirstlane_b32 s41, v50
    v_and_b32 v66, 31, v1
    v_lshlrev_b32 v66, 3, v66
    v_add_u32 v67, s13, v66
    v_mov_b32 v30, v71
    v_mov_b32 v79, v69
    s_waitcnt lgkmcnt(0)
    v_pk_mul_f32 v[96:97], v[96:97], v[80:81]
    v_pk_mul_f32 v[112:113], v[112:113], v[80:81]
    v_pk_mul_f32 v[98:99], v[98:99], v[82:83]
    v_pk_mul_f32 v[114:115], v[114:115], v[82:83]
    v_pk_fma_f32 v[68:69], v[96:97], v[48:49], v[98:99] op_sel:[0,0,0] op_sel_hi:[1,0,1]
    v_pk_fma_f32 v[70:71], v[112:113], v[48:49], v[114:115] op_sel:[0,0,0] op_sel_hi:[1,0,1]
    v_pk_fma_f32 v[68:69], v[112:113], v[48:49], v[68:69] op_sel:[0,1,0] op_sel_hi:[1,1,1] neg_lo:[1,0,0] neg_hi:[1,0,0]
    v_pk_fma_f32 v[70:71], v[96:97], v[48:49], v[70:71] op_sel:[0,1,0] op_sel_hi:[1,1,1]
    v_pk_mul_f32 v[100:101], v[100:101], v[84:85]
    v_pk_mul_f32 v[116:117], v[116:117], v[84:85]
    v_pk_fma_f32 v[72:73], v[68:69], v[48:49], v[100:101] op_sel:[0,0,0] op_sel_hi:[1,0,1]
    v_pk_fma_f32 v[74:75], v[70:71], v[48:49], v[116:117] op_sel:[0,0,0] op_sel_hi:[1,0,1]
    v_pk_fma_f32 v[72:73], v[70:71], v[48:49], v[72:73] op_sel:[0,1,0] op_sel_hi:[1,1,1] neg_lo:[1,0,0] neg_hi:[1,0,0]
    v_pk_fma_f32 v[74:75], v[68:69], v[48:49], v[74:75] op_sel:[0,1,0] op_sel_hi:[1,1,1]
    v_pk_mul_f32 v[102:103], v[102:103], v[86:87]
    v_pk_mul_f32 v[118:119], v[118:119], v[86:87]
    v_pk_fma_f32 v[68:69], v[72:73], v[48:49], v[102:103] op_sel:[0,0,0] op_sel_hi:[1,0,1]
    v_pk_fma_f32 v[70:71], v[74:75], v[48:49], v[118:119] op_sel:[0,0,0] op_sel_hi:[1,0,1]
    v_pk_fma_f32 v[68:69], v[74:75], v[48:49], v[68:69] op_sel:[0,1,0] op_sel_hi:[1,1,1] neg_lo:[1,0,0] neg_hi:[1,0,0]
    v_pk_fma_f32 v[70:71], v[72:73], v[48:49], v[70:71] op_sel:[0,1,0] op_sel_hi:[1,1,1]
    v_pk_mul_f32 v[104:105], v[104:105], v[88:89]
    v_pk_mul_f32 v[120:121], v[120:121], v[88:89]
    v_pk_fma_f32 v[72:73], v[68:69], v[48:49], v[104:105] op_sel:[0,0,0] op_sel_hi:[1,0,1]
    v_pk_fma_f32 v[74:75], v[70:71], v[48:49], v[120:121] op_sel:[0,0,0] op_sel_hi:[1,0,1]
    v_pk_fma_f32 v[72:73], v[70:71], v[48:49], v[72:73] op_sel:[0,1,0] op_sel_hi:[1,1,1] neg_lo:[1,0,0] neg_hi:[1,0,0]
    v_pk_fma_f32 v[74:75], v[68:69], v[48:49], v[74:75] op_sel:[0,1,0] op_sel_hi:[1,1,1]
    v_pk_mul_f32 v[106:107], v[106:107], v[90:91]
    v_pk_mul_f32 v[122:123], v[122:123], v[90:91]
    v_pk_fma_f32 v[68:69], v[72:73], v[48:49], v[106:107] op_sel:[0,0,0] op_sel_hi:[1,0,1]
    v_pk_fma_f32 v[70:71], v[74:75], v[48:49], v[122:123] op_sel:[0,0,0] op_sel_hi:[1,0,1]
    v_pk_fma_f32 v[68:69], v[74:75], v[48:49], v[68:69] op_sel:[0,1,0] op_sel_hi:[1,1,1] neg_lo:[1,0,0] neg_hi:[1,0,0]
    v_pk_fma_f32 v[70:71], v[72:73], v[48:49], v[70:71] op_sel:[0,1,0] op_sel_hi:[1,1,1]
    v_pk_mul_f32 v[108:109], v[108:109], v[92:93]
    v_pk_mul_f32 v[124:125], v[124:125], v[92:93]
    v_pk_fma_f32 v[72:73], v[68:69], v[48:49], v[108:109] op_sel:[0,0,0] op_sel_hi:[1,0,1]
    v_pk_fma_f32 v[74:75], v[70:71], v[48:49], v[124:125] op_sel:[0,0,0] op_sel_hi:[1,0,1]
    v_pk_fma_f32 v[72:73], v[70:71], v[48:49], v[72:73] op_sel:[0,1,0] op_sel_hi:[1,1,1] neg_lo:[1,0,0] neg_hi:[1,0,0]
    v_pk_fma_f32 v[74:75], v[68:69], v[48:49], v[74:75] op_sel:[0,1,0] op_sel_hi:[1,1,1]
    v_pk_mul_f32 v[110:111], v[110:111], v[94:95]
    v_pk_mul_f32 v[126:127], v[126:127], v[94:95]
    v_pk_fma_f32 v[68:69], v[72:73], v[48:49], v[110:111] op_sel:[0,0,0] op_sel_hi:[1,0,1]
    v_pk_fma_f32 v[70:71], v[74:75], v[48:49], v[126:127] op_sel:[0,0,0] op_sel_hi:[1,0,1]
    v_pk_fma_f32 v[68:69], v[74:75], v[48:49], v[68:69] op_sel:[0,1,0] op_sel_hi:[1,1,1] neg_lo:[1,0,0] neg_hi:[1,0,0]
    v_pk_fma_f32 v[70:71], v[72:73], v[48:49], v[70:71] op_sel:[0,1,0] op_sel_hi:[1,1,1]
    v_fmac_f32 v69, v32, v68
    v_fmac_f32 v71, v32, v70
    v_fmac_f32 v69, v34, v70
    v_fmac_f32 v71, v33, v68
    v_mov_b32 v72, v69
    v_mov_b32 v76, v69
    v_mov_b32 v73, v71
    v_mov_b32 v77, v71
    v_permlane32_swap_b32 v72, v76
    s_nop 0
    v_permlane32_swap_b32 v73, v77
    v_fmac_f32 v76, v38, v72
    v_fmac_f32 v77, v38, v73
    v_fma_f32 v76, -v39, v73, v76
    v_fmac_f32 v77, v39, v72
    ds_write_b64 v67, v[76:77] offset:40320
    s_waitcnt vmcnt(15) lgkmcnt(0)
    s_barrier
    ds_read_b64 v[80:81], v66 offset:40320
    ds_read_b64 v[82:83], v66 offset:48512
    ds_read_b64 v[84:85], v66 offset:56704
    ds_read_b64_tr_b16 a[112:113], v24 offset:32768
    ds_read_b64_tr_b16 a[114:115], v24 offset:33664
    ds_read_b64_tr_b16 a[116:117], v24 offset:32800
    ds_read_b64_tr_b16 a[118:119], v24 offset:33696
    ds_read_b64_tr_b16 a[120:121], v24 offset:32832
    ds_read_b64_tr_b16 a[122:123], v24 offset:33728
    ds_read_b64_tr_b16 a[124:125], v24 offset:32864
    ds_read_b64_tr_b16 a[126:127], v24 offset:33760
    ds_read_b64_tr_b16 a[128:129], v24 offset:32896
    ds_read_b64_tr_b16 a[130:131], v24 offset:33792
    ds_read_b64_tr_b16 a[132:133], v24 offset:32928
    ds_read_b64_tr_b16 a[134:135], v24 offset:33824
    ds_read_b64_tr_b16 a[136:137], v24 offset:32960
    ds_read_b64_tr_b16 a[138:139], v24 offset:33856
    s_waitcnt lgkmcnt(6)
    v_mfma_f32_32x32x16_bf16 a[0:15], a[112:115], v[128:131], 0
    ds_read_b64_tr_b16 a[140:141], v24 offset:36352
    ds_read_b64_tr_b16 a[142:143], v24 offset:37248
    buffer_load_dwordx4 v17, s[60:63], s98 offen offset:1024 lds
    s_waitcnt lgkmcnt(15)
    v_mov_b32 v50, 0
    v_mov_b32 v51, 0
    s_cmp_le_u32 s3, 0
    s_cbranch_scc1 L_pdone
    v_fma_f32 v64, v40, v50, v80
    v_fma_f32 v65, v40, v51, v81
    v_fma_f32 v64, -v41, v51, v64
    v_fma_f32 v51, v41, v50, v65
    v_mov_b32 v50, v64
    s_cmp_le_u32 s3, 1
    s_cbranch_scc1 L_pdone
    v_fma_f32 v64, v40, v50, v82
    v_fma_f32 v65, v40, v51, v83
    v_fma_f32 v64, -v41, v51, v64
    v_fma_f32 v51, v41, v50, v65
    v_mov_b32 v50, v64
    s_cmp_le_u32 s3, 2
    s_cbranch_scc1 L_pdone
    v_fma_f32 v64, v40, v50, v84
    v_fma_f32 v65, v40, v51, v85
    v_fma_f32 v64, -v41, v51, v64
    v_fma_f32 v51, v41, v50, v65
    v_mov_b32 v50, v64
L_pdone:
    v_mfma_f32_32x32x16_bf16 a[16:31], a[116:119], v[128:131], 0
    ds_read_b64_tr_b16 a[112:113], v24 offset:36384
    ds_read_b64_tr_b16 a[114:115], v24 offset:37280
    v_fmac_f32 v76, v40, v50
    v_fmac_f32 v77, v40, v51
    v_fma_f32 v76, -v41, v51, v76
    v_fmac_f32 v77, v41, v50
    v_mfma_f32_32x32x16_bf16 a[32:47], a[120:123], v[128:131], 0
    ds_read_b64_tr_b16 a[116:117], v24 offset:36416
    ds_read_b64_tr_b16 a[118:119], v24 offset:37312
    buffer_load_dwordx4 v18, s[60:63], s98 offen offset:2048 lds
    s_cmp_eq_u32 s4, 15
    s_cselect_b32 s99, 0, -1
    v_and_b32 v76, s99, v76
    v_and_b32 v77, s99, v77
    v_mfma_f32_32x32x16_bf16 a[48:63], a[124:127], v[128:131], 0
    ds_read_b64_tr_b16 a[120:121], v24 offset:36448
    ds_read_b64_tr_b16 a[122:123], v24 offset:37344
    v_mov_b32 v78, s41
    buffer_store_dwordx4 v[76:79], v19, s[84:87], 0 offen sc1
    v_fmac_f32 v72, v38, v50
    v_fmac_f32 v73, v38, v51
    s_waitcnt lgkmcnt(6)
    v_mfma_f32_32x32x16_bf16 a[64:79], a[128:131], v[128:131], 0
    ds_read_b64_tr_b16 a[124:125], v24 offset:36480
    ds_read_b64_tr_b16 a[126:127], v24 offset:37376
    v_fma_f32 v72, -v39, v51, v72
    v_fmac_f32 v73, v39, v50
    v_cndmask_b32 v50, v50, v72, s[96:97]
    v_mfma_f32_32x32x16_bf16 a[80:95], a[132:135], v[128:131], 0
    ds_read_b64_tr_b16 a[128:129], v24 offset:36512
    ds_read_b64_tr_b16 a[130:131], v24 offset:37408
    v_cndmask_b32 v51, v51, v73, s[96:97]
    v_lshlrev_b32 v65, 12, v2
    v_lshlrev_b32 v64, 1, v66
    v_add_u32 v67, 7680, v64
    v_mfma_f32_32x32x16_bf16 a[96:111], a[136:139], v[128:131], 0
    ds_read_b64_tr_b16 a[132:133], v24 offset:36544
    ds_read_b64_tr_b16 a[134:135], v24 offset:37440
    s_add_u32 m0, s93, 0x20000
    s_mul_i32 s98, s100, 229376
    s_add_u32 s98, s98, s89
    buffer_load_dwordx4 v12, s[60:63], s98 offen offset:0 lds
    v_mfma_f32_32x32x16_bf16 a[0:15], a[140:143], v[132:135], a[0:15]
    ds_read_b64_tr_b16 a[136:137], v24 offset:49152
    ds_read_b64_tr_b16 a[138:139], v24 offset:50048
    v_sub_u32 v64, v64, v65
    s_lshl_b32 s99, s3, 1
    s_add_u32 s99, s99, s4
    s_lshl_b32 s99, s99, 9
    s_sub_u32 s99, s99, 4096
    v_add_u32 v68, s99, v64
    s_waitcnt lgkmcnt(6)
    v_mfma_f32_32x32x16_bf16 a[16:31], a[112:115], v[132:135], a[16:31]
    ds_read_b64_tr_b16 a[140:141], v24 offset:49184
    ds_read_b64_tr_b16 a[142:143], v24 offset:50080
    buffer_store_dwordx4 a[208:211], v31, s[80:83], s20 offen offset:0 sc1
    v_add_u32 v69, 512, v68
    v_min_u32 v68, v68, v67
    v_mfma_f32_32x32x16_bf16 a[32:47], a[116:119], v[132:135], a[32:47]
    ds_read_b64_tr_b16 a[112:113], v24 offset:49216
    ds_read_b64_tr_b16 a[114:115], v24 offset:50112
    v_min_u32 v69, v69, v67
    v_lshlrev_b32 v70, 3, v1
    v_add_u32 v71, s13, v70
    v_mul_f32 v64, v43, v43
    v_mfma_f32_32x32x16_bf16 a[48:63], a[120:123], v[132:135], a[48:63]
    ds_read_b64_tr_b16 a[116:117], v24 offset:49248
    ds_read_b64_tr_b16 a[118:119], v24 offset:50144
    buffer_load_dwordx4 v13, s[60:63], s98 offen offset:1024 lds
    v_add_f32 v65, v42, v42
    v_fma_f32 v38, v42, v42, -v64
    v_mul_f32 v39, v65, v43
    v_mfma_f32_32x32x16_bf16 a[64:79], a[124:127], v[132:135], a[64:79]
    ds_read_b64_tr_b16 a[120:121], v24 offset:49280
    ds_read_b64_tr_b16 a[122:123], v24 offset:50176
    v_mul_f32 v64, v37, v96
    v_mul_f32 v96, v36, v96
    v_fma_f32 v96, -v37, v112, v96
    v_fma_f32 v112, v36, v112, v64
    s_waitcnt lgkmcnt(6)
    v_mfma_f32_32x32x16_bf16 a[80:95], a[128:131], v[132:135], a[80:95]
    ds_read_b64_tr_b16 a[124:125], v24 offset:49312
    ds_read_b64_tr_b16 a[126:127], v24 offset:50208
    v_mul_f32 v64, v37, v97
    v_mul_f32 v97, v36, v97
    v_fma_f32 v97, -v37, v113, v97
    v_mfma_f32_32x32x16_bf16 a[96:111], a[132:135], v[132:135], a[96:111]
    ds_read_b64_tr_b16 a[128:129], v24 offset:49344
    ds_read_b64_tr_b16 a[130:131], v24 offset:50240
    v_fma_f32 v113, v36, v113, v64
    v_mul_f32 v64, v37, v98
    v_mul_f32 v98, v36, v98
    v_fma_f32 v98, -v37, v114, v98
    v_mfma_f32_32x32x16_bf16 a[0:15], a[136:139], v[136:139], a[0:15]
    ds_read_b64_tr_b16 a[132:133], v24 offset:52736
    ds_read_b64_tr_b16 a[134:135], v24 offset:53632
    buffer_load_dwordx4 v14, s[60:63], s98 offen offset:2048 lds
    v_fma_f32 v114, v36, v114, v64
    v_mul_f32 v64, v37, v99
    v_mul_f32 v99, v36, v99
    v_mfma_f32_32x32x16_bf16 a[16:31], a[140:143], v[136:139], a[16:31]
    ds_read_b64_tr_b16 a[136:137], v24 offset:52768
    ds_read_b64_tr_b16 a[138:139], v24 offset:53664
    v_fma_f32 v99, -v37, v115, v99
    v_fma_f32 v115, v36, v115, v64
    v_mul_f32 v64, v37, v100
    v_mul_f32 v100, v36, v100
    s_waitcnt lgkmcnt(6)
    v_mfma_f32_32x32x16_bf16 a[32:47], a[112:115], v[136:139], a[32:47]
    ds_read_b64_tr_b16 a[140:141], v24 offset:52800
    ds_read_b64_tr_b16 a[142:143], v24 offset:53696
    buffer_store_dwordx4 a[208:211], v31, s[80:83], s20 offen offset:1024 sc1
    v_fma_f32 v100, -v37, v116, v100
    v_fma_f32 v116, v36, v116, v64
    v_mfma_f32_32x32x16_bf16 a[48:63], a[116:119], v[136:139], a[48:63]
    ds_read_b64_tr_b16 a[112:113], v24 offset:52832
    ds_read_b64_tr_b16 a[114:115], v24 offset:53728
    v_mul_f32 v64, v37, v101
    v_mul_f32 v101, v36, v101
    v_fma_f32 v101, -v37, v117, v101
    v_fma_f32 v117, v36, v117, v64
    v_mfma_f32_32x32x16_bf16 a[64:79], a[120:123], v[136:139], a[64:79]
    ds_read_b64_tr_b16 a[116:117], v24 offset:52864
    ds_read_b64_tr_b16 a[118:119], v24 offset:53760
    buffer_load_dwordx4 v15, s[60:63], s98 offen offset:3072 lds
    v_mul_f32 v64, v37, v102
    v_mul_f32 v102, v36, v102
    v_fma_f32 v102, -v37, v118, v102
    v_mfma_f32_32x32x16_bf16 a[80:95], a[124:127], v[136:139], a[80:95]
    ds_read_b64_tr_b16 a[120:121], v24 offset:52896
    ds_read_b64_tr_b16 a[122:123], v24 offset:53792
    v_fma_f32 v118, v36, v118, v64
    v_mul_f32 v64, v37, v103
    v_mul_f32 v103, v36, v103
    v_fma_f32 v103, -v37, v119, v103
    s_waitcnt lgkmcnt(6)
    v_mfma_f32_32x32x16_bf16 a[96:111], a[128:131], v[136:139], a[96:111]
    ds_read_b64_tr_b16 a[124:125], v24 offset:52928
    ds_read_b64_tr_b16 a[126:127], v24 offset:53824
    v_fma_f32 v119, v36, v119, v64
    v_mul_f32 v64, v37, v104
    v_mul_f32 v104, v36, v104
    v_mfma_f32_32x32x16_bf16 a[0:15], a[132:135], v[140:143], a[0:15]
    s_waitcnt vmcnt(14)
    s_barrier
    ds_read_b64_tr_b16 a[128:129], v25 offset:0
    ds_read_b64_tr_b16 a[130:131], v25 offset:896
    v_fma_f32 v104, -v37, v120, v104
    v_fma_f32 v120, v36, v120, v64
    v_mfma_f32_32x32x16_bf16 a[16:31], a[136:139], v[140:143], a[16:31]
    ds_read_b64_tr_b16 a[132:133], v25 offset:32
    ds_read_b64_tr_b16 a[134:135], v25 offset:928
    s_add_u32 m0, s93, 0x21000
    s_add_u32 s100, s100, 1
    s_and_b32 s100, s100, 7
    buffer_load_dwordx4 v16, s[60:63], s98 offen offset:0 lds
    v_mfma_f32_32x32x16_bf16 a[32:47], a[140:143], v[140:143], a[32:47]
    ds_read_b64_tr_b16 a[136:137], v25 offset:64
    ds_read_b64_tr_b16 a[138:139], v25 offset:960
    v_mul_f32 v64, v37, v105
    v_mul_f32 v105, v36, v105
    v_fma_f32 v105, -v37, v121, v105
    v_fma_f32 v121, v36, v121, v64
    s_waitcnt lgkmcnt(6)
    v_mfma_f32_32x32x16_bf16 a[48:63], a[112:115], v[140:143], a[48:63]
    ds_read_b64_tr_b16 a[140:141], v25 offset:96
    ds_read_b64_tr_b16 a[142:143], v25 offset:992
    buffer_store_dwordx4 a[208:211], v31, s[80:83], s20 offen offset:2048 sc1
    v_mul_f32 v64, v37, v106
    v_mul_f32 v106, v36, v106
    v_mfma_f32_32x32x16_bf16 a[64:79], a[116:119], v[140:143], a[64:79]
    ds_read_b64_tr_b16 a[112:113], v25 offset:128
    ds_read_b64_tr_b16 a[114:115], v25 offset:1024
    v_fma_f32 v106, -v37, v122, v106
    v_fma_f32 v122, v36, v122, v64
    v_mul_f32 v64, v37, v107
    v_mul_f32 v107, v36, v107
    v_mfma_f32_32x32x16_bf16 a[80:95], a[120:123], v[140:143], a[80:95]
    ds_read_b64_tr_b16 a[116:117], v25 offset:160
    ds_read_b64_tr_b16 a[118:119], v25 offset:1056
    buffer_load_dwordx4 v17, s[60:63], s98 offen offset:1024 lds
    v_fma_f32 v107, -v37, v123, v107
    v_fma_f32 v123, v36, v123, v64
    v_mul_f32 v64, v37, v108
    v_mfma_f32_32x32x16_bf16 a[96:111], a[124:127], v[140:143], a[96:111]
    ds_read_b64_tr_b16 a[120:121], v25 offset:192
    ds_read_b64_tr_b16 a[122:123], v25 offset:1088
    v_mul_f32 v108, v36, v108
    v_fma_f32 v108, -v37, v124, v108
    v_fma_f32 v124, v36, v124, v64
    v_mul_f32 v64, v37, v109
    s_waitcnt lgkmcnt(6)
    v_mfma_f32_32x32x16_bf16 a[0:15], a[128:131], v[144:147], a[0:15]
    ds_read_b64_tr_b16 a[124:125], v25 offset:3584
    ds_read_b64_tr_b16 a[126:127], v25 offset:4480
    buffer_load_dwordx3 v[72:74], v68, s[84:87], 0 offen sc1
    buffer_load_dwordx3 v[76:78], v69, s[84:87], 0 offen sc1
    v_mul_f32 v109, v36, v109
    v_mfma_f32_32x32x16_bf16 a[16:31], a[132:135], v[144:147], a[16:31]
    ds_read_b64_tr_b16 a[128:129], v25 offset:3616
    ds_read_b64_tr_b16 a[130:131], v25 offset:4512
    v_fma_f32 v109, -v37, v125, v109
    v_fma_f32 v125, v36, v125, v64
    v_mul_f32 v64, v37, v110
    v_mul_f32 v110, v36, v110
    v_mfma_f32_32x32x16_bf16 a[32:47], a[136:139], v[144:147], a[32:47]
    ds_read_b64_tr_b16 a[132:133], v25 offset:3648
    ds_read_b64_tr_b16 a[134:135], v25 offset:4544
    buffer_load_dwordx4 v18, s[60:63], s98 offen offset:2048 lds
    v_fma_f32 v110, -v37, v126, v110
    v_fma_f32 v126, v36, v126, v64
    v_mul_f32 v64, v37, v111
    v_mfma_f32_32x32x16_bf16 a[48:63], a[140:143], v[144:147], a[48:63]
    ds_read_b64_tr_b16 a[136:137], v25 offset:3680
    ds_read_b64_tr_b16 a[138:139], v25 offset:4576
    v_mul_f32 v111, v36, v111
    v_fma_f32 v111, -v37, v127, v111
    v_fma_f32 v127, v36, v127, v64
    s_waitcnt lgkmcnt(6)
    v_mfma_f32_32x32x16_bf16 a[64:79], a[112:115], v[144:147], a[64:79]
    ds_read_b64_tr_b16 a[140:141], v25 offset:3712
    ds_read_b64_tr_b16 a[142:143], v25 offset:4608
    buffer_store_dwordx4 a[208:211], v3, s[80:83], 0 offen sc1
    v_mfma_f32_32x32x16_bf16 a[80:95], a[116:119], v[144:147], a[80:95]
    ds_read_b64_tr_b16 a[112:113], v25 offset:3744
    ds_read_b64_tr_b16 a[114:115], v25 offset:4640
    v_mfma_f32_32x32x16_bf16 a[96:111], a[120:123], v[144:147], a[96:111]
    ds_read_b64_tr_b16 a[116:117], v25 offset:3776
    ds_read_b64_tr_b16 a[118:119], v25 offset:4672
    s_add_u32 m0, s93, 0x0
    s_mul_i32 s98, s100, 229376
    s_add_u32 s98, s98, s89
    buffer_load_dwordx4 v12, s[60:63], s98 offen offset:0 lds
    v_mfma_f32_32x32x16_bf16 a[0:15], a[124:127], v[148:151], a[0:15]
    ds_read_b64_tr_b16 a[120:121], v25 offset:16384
    ds_read_b64_tr_b16 a[122:123], v25 offset:17280
    s_waitcnt lgkmcnt(6)
    v_mfma_f32_32x32x16_bf16 a[16:31], a[128:131], v[148:151], a[16:31]
    ds_read_b64_tr_b16 a[124:125], v25 offset:16416
    ds_read_b64_tr_b16 a[126:127], v25 offset:17312
    v_mfma_f32_32x32x16_bf16 a[32:47], a[132:135], v[148:151], a[32:47]
    ds_read_b64_tr_b16 a[128:129], v25 offset:16448
    ds_read_b64_tr_b16 a[130:131], v25 offset:17344
    v_mfma_f32_32x32x16_bf16 a[48:63], a[136:139], v[148:151], a[48:63]
    ds_read_b64_tr_b16 a[132:133], v25 offset:16480
    ds_read_b64_tr_b16 a[134:135], v25 offset:17376
    buffer_load_dwordx4 v13, s[60:63], s98 offen offset:1024 lds
    v_mfma_f32_32x32x16_bf16 a[64:79], a[140:143], v[148:151], a[64:79]
    ds_read_b64_tr_b16 a[136:137], v25 offset:16512
    ds_read_b64_tr_b16 a[138:139], v25 offset:17408
    s_waitcnt lgkmcnt(6)
    v_mfma_f32_32x32x16_bf16 a[80:95], a[112:115], v[148:151], a[80:95]
    ds_read_b64_tr_b16 a[140:141], v25 offset:16544
    ds_read_b64_tr_b16 a[142:143], v25 offset:17440
    buffer_store_dwordx4 a[208:211], v31, s[80:83], s20 offen offset:3072 sc1
    v_mfma_f32_32x32x16_bf16 a[96:111], a[116:119], v[148:151], a[96:111]
    ds_read_b64_tr_b16 a[112:113], v25 offset:16576
    ds_read_b64_tr_b16 a[114:115], v25 offset:17472
    v_mfma_f32_32x32x16_bf16 a[0:15], a[120:123], v[152:155], a[0:15]
    ds_read_b64_tr_b16 a[116:117], v25 offset:19968
    ds_read_b64_tr_b16 a[118:119], v25 offset:20864
    buffer_load_dwordx4 v14, s[60:63], s98 offen offset:2048 lds
    v_mfma_f32_32x32x16_bf16 a[16:31], a[124:127], v[152:155], a[16:31]
    ds_read_b64_tr_b16 a[120:121], v25 offset:20000
    ds_read_b64_tr_b16 a[122:123], v25 offset:20896
    s_waitcnt lgkmcnt(6)
    v_mfma_f32_32x32x16_bf16 a[32:47], a[128:131], v[152:155], a[32:47]
    ds_read_b64_tr_b16 a[124:125], v25 offset:20032
    ds_read_b64_tr_b16 a[126:127], v25 offset:20928
    v_mfma_f32_32x32x16_bf16 a[48:63], a[132:135], v[152:155], a[48:63]
    ds_read_b64_tr_b16 a[128:129], v25 offset:20064
    ds_read_b64_tr_b16 a[130:131], v25 offset:20960
    v_mfma_f32_32x32x16_bf16 a[64:79], a[136:139], v[152:155], a[64:79]
    ds_read_b64_tr_b16 a[132:133], v25 offset:20096
    ds_read_b64_tr_b16 a[134:135], v25 offset:20992
    buffer_load_dwordx4 v15, s[60:63], s98 offen offset:3072 lds
    v_mfma_f32_32x32x16_bf16 a[80:95], a[140:143], v[152:155], a[80:95]
    ds_read_b64_tr_b16 a[136:137], v25 offset:20128
    ds_read_b64_tr_b16 a[138:139], v25 offset:21024
    s_waitcnt lgkmcnt(6)
    v_mfma_f32_32x32x16_bf16 a[96:111], a[112:115], v[152:155], a[96:111]
    ds_read_b64_tr_b16 a[140:141], v25 offset:20160
    ds_read_b64_tr_b16 a[142:143], v25 offset:21056
    buffer_store_dwordx4 a[208:211], v31, s[80:83], s17 offen offset:0 sc1
    v_mfma_f32_32x32x16_bf16 a[0:15], a[116:119], v[156:159], a[0:15]
    s_waitcnt vmcnt(20)
    s_barrier
    ds_read_b64_tr_b16 a[112:113], v25 offset:32768
    ds_read_b64_tr_b16 a[114:115], v25 offset:33664
    v_mfma_f32_32x32x16_bf16 a[16:31], a[120:123], v[156:159], a[16:31]
    ds_read_b64_tr_b16 a[116:117], v25 offset:32800
    ds_read_b64_tr_b16 a[118:119], v25 offset:33696
    s_add_u32 m0, s93, 0x1000
    s_add_u32 s100, s100, 1
    s_and_b32 s100, s100, 7
    buffer_load_dwordx4 v16, s[60:63], s98 offen offset:0 lds
    v_mfma_f32_32x32x16_bf16 a[32:47], a[124:127], v[156:159], a[32:47]
    ds_read_b64_tr_b16 a[120:121], v25 offset:32832
    ds_read_b64_tr_b16 a[122:123], v25 offset:33728
    s_waitcnt lgkmcnt(6)
    v_mfma_f32_32x32x16_bf16 a[48:63], a[128:131], v[156:159], a[48:63]
    ds_read_b64_tr_b16 a[124:125], v25 offset:32864
    ds_read_b64_tr_b16 a[126:127], v25 offset:33760
    v_mfma_f32_32x32x16_bf16 a[64:79], a[132:135], v[156:159], a[64:79]
    ds_read_b64_tr_b16 a[128:129], v25 offset:32896
    ds_read_b64_tr_b16 a[130:131], v25 offset:33792
    v_mfma_f32_32x32x16_bf16 a[80:95], a[136:139], v[156:159], a[80:95]
    ds_read_b64_tr_b16 a[132:133], v25 offset:32928
    ds_read_b64_tr_b16 a[134:135], v25 offset:33824
    buffer_load_dwordx4 v17, s[60:63], s98 offen offset:1024 lds
    v_mfma_f32_32x32x16_bf16 a[96:111], a[140:143], v[156:159], a[96:111]
    ds_read_b64_tr_b16 a[136:137], v25 offset:32960
    ds_read_b64_tr_b16 a[138:139], v25 offset:33856
    s_waitcnt lgkmcnt(6)
    v_mfma_f32_32x32x16_bf16 a[0:15], a[112:115], v[160:163], a[0:15]
    ds_read_b64_tr_b16 a[140:141], v25 offset:36352
    ds_read_b64_tr_b16 a[142:143], v25 offset:37248
    buffer_store_dwordx4 a[208:211], v31, s[80:83], s17 offen offset:1024 sc1
    v_mfma_f32_32x32x16_bf16 a[16:31], a[116:119], v[160:163], a[16:31]
    ds_read_b64_tr_b16 a[112:113], v25 offset:36384
    ds_read_b64_tr_b16 a[114:115], v25 offset:37280
    v_mfma_f32_32x32x16_bf16 a[32:47], a[120:123], v[160:163], a[32:47]
    ds_read_b64_tr_b16 a[116:117], v25 offset:36416
    ds_read_b64_tr_b16 a[118:119], v25 offset:37312
    buffer_load_dwordx4 v18, s[60:63], s98 offen offset:2048 lds
    v_mfma_f32_32x32x16_bf16 a[48:63], a[124:127], v[160:163], a[48:63]
    ds_read_b64_tr_b16 a[120:121], v25 offset:36448
    ds_read_b64_tr_b16 a[122:123], v25 offset:37344
    s_waitcnt lgkmcnt(6)
    v_mfma_f32_32x32x16_bf16 a[64:79], a[128:131], v[160:163], a[64:79]
    ds_read_b64_tr_b16 a[124:125], v25 offset:36480
    ds_read_b64_tr_b16 a[126:127], v25 offset:37376
    s_waitcnt vmcnt(12)
    v_xor_b32 v64, s41, v74
    v_bitop3_b32 v64, v64, v78, s41 bitop3:0xf6
    v_cmp_ne_u32 vcc, 0, v64
    s_nop 0
    s_cbranch_vccnz L_slow_e
L_back_e:
    v_mfma_f32_32x32x16_bf16 a[80:95], a[132:135], v[160:163], a[80:95]
    ds_read_b64_tr_b16 a[128:129], v25 offset:36512
    ds_read_b64_tr_b16 a[130:131], v25 offset:37408
    v_fmac_f32 v76, v42, v72
    v_fmac_f32 v77, v42, v73
    v_fma_f32 v76, -v43, v73, v76
    v_fmac_f32 v77, v43, v72
    v_mfma_f32_32x32x16_bf16 a[96:111], a[136:139], v[160:163], a[96:111]
    ds_read_b64_tr_b16 a[132:133], v25 offset:36544
    ds_read_b64_tr_b16 a[134:135], v25 offset:37440
    s_add_u32 m0, s93, 0x8000
    s_mul_i32 s98, s100, 229376
    s_add_u32 s98, s98, s89
    buffer_load_dwordx4 v12, s[60:63], s98 offen offset:0 lds
    ds_write_b64 v71, v[76:77] offset:40064
    v_mfma_f32_32x32x16_bf16 a[0:15], a[140:143], v[164:167], a[0:15]
    ds_read_b64_tr_b16 a[136:137], v25 offset:49152
    ds_read_b64_tr_b16 a[138:139], v25 offset:50048
    s_waitcnt lgkmcnt(2)
    s_barrier
    ds_read_b64 v[80:81], v70 offset:40064
    ds_read_b64 v[82:83], v70 offset:48256
    ds_read_b64 v[84:85], v70 offset:56448
    ds_read_b64 v[86:87], v70 offset:64640
    s_waitcnt lgkmcnt(11)
    v_mfma_f32_32x32x16_bf16 a[16:31], a[112:115], v[164:167], a[16:31]
    ds_read_b64_tr_b16 a[140:141], v25 offset:49184
    ds_read_b64_tr_b16 a[142:143], v25 offset:50080
    buffer_store_dwordx4 a[208:211], v31, s[80:83], s17 offen offset:2048 sc1
    v_mfma_f32_32x32x16_bf16 a[32:47], a[116:119], v[164:167], a[32:47]
    ds_read_b64_tr_b16 a[112:113], v25 offset:49216
    ds_read_b64_tr_b16 a[114:115], v25 offset:50112
    v_mfma_f32_32x32x16_bf16 a[48:63], a[120:123], v[164:167], a[48:63]
    ds_read_b64_tr_b16 a[116:117], v25 offset:49248
    ds_read_b64_tr_b16 a[118:119], v25 offset:50144
    buffer_load_dwordx4 v13, s[60:63], s98 offen offset:1024 lds
    s_waitcnt lgkmcnt(6)
    v_fmac_f32 v82, v38, v80
    v_fmac_f32 v83, v38, v81
    v_fma_f32 v82, -v39, v81, v82
    v_fmac_f32 v83, v39, v80
    v_mfma_f32_32x32x16_bf16 a[64:79], a[124:127], v[164:167], a[64:79]
    ds_read_b64_tr_b16 a[120:121], v25 offset:49280
    ds_read_b64_tr_b16 a[122:123], v25 offset:50176
    v_fmac_f32 v84, v38, v82
    v_fmac_f32 v85, v38, v83
    v_fma_f32 v84, -v39, v83, v84
    v_fmac_f32 v85, v39, v82
    v_fmac_f32 v86, v38, v84
    v_fmac_f32 v87, v38, v85
    s_waitcnt lgkmcnt(6)
    v_mfma_f32_32x32x16_bf16 a[80:95], a[128:131], v[164:167], a[80:95]
    ds_read_b64_tr_b16 a[124:125], v25 offset:49312
    ds_read_b64_tr_b16 a[126:127], v25 offset:50208
    v_fma_f32 v86, -v39, v85, v86
    v_fmac_f32 v87, v39, v84
    v_mov_b32 v68, v86
    v_mov_b32 v69, v87
    v_lshlrev_b32 v66, 3, v66
    v_mfma_f32_32x32x16_bf16 a[96:111], a[132:135], v[164:167], a[96:111]
    ds_read_b64_tr_b16 a[128:129], v25 offset:49344
    ds_read_b64_tr_b16 a[130:131], v25 offset:50240
    v_bfe_u32 v67, v1, 1, 2
    v_permlane32_swap_b32 v68, v86
    v_permlane32_swap_b32 v69, v87
    v_lshlrev_b32 v64, 1, v2
    v_xor_b32 v67, v67, v64
    v_lshl_add_u32 v66, v67, 4, v66
    v_mfma_f32_32x32x16_bf16 a[0:15], a[136:139], v[168:171], a[0:15]
    ds_read_b64_tr_b16 a[132:133], v25 offset:52736
    ds_read_b64_tr_b16 a[134:135], v25 offset:53632
    buffer_load_dwordx4 v14, s[60:63], s98 offen offset:2048 lds
    v_fmac_f32 v68, v44, v86
    v_fmac_f32 v69, v44, v87
    v_fma_f32 v68, -v45, v87, v68
    v_fmac_f32 v69, v45, v86
    v_fmac_f32 v50, v46, v68
    v_mfma_f32_32x32x16_bf16 a[16:31], a[140:143], v[168:171], a[16:31]
    ds_read_b64_tr_b16 a[136:137], v25 offset:52768
    ds_read_b64_tr_b16 a[138:139], v25 offset:53664
    v_fmac_f32 v51, v46, v69
    v_fma_f32 v50, -v47, v69, v50
    v_fmac_f32 v51, v47, v68
    v_mul_f32 v64, v50, v36
    v_mul_f32 v65, v50, v37
    v_fma_f32 v64, -v51, v37, v64
    s_waitcnt lgkmcnt(6)
    v_mfma_f32_32x32x16_bf16 a[32:47], a[112:115], v[168:171], a[32:47]
    ds_read_b64_tr_b16 a[140:141], v25 offset:52800
    ds_read_b64_tr_b16 a[142:143], v25 offset:53696
    buffer_store_dwordx4 a[208:211], v31, s[80:83], s26 offen offset:0 sc1
    v_fma_f32 v51, v51, v36, v65
    v_mov_b32 v50, v64
    ds_read_b128 v[80:83], v30 offset:40576
    ds_read_b128 v[84:87], v30 offset:40592
    v_mfma_f32_32x32x16_bf16 a[48:63], a[116:119], v[168:171], a[48:63]
    ds_read_b64_tr_b16 a[112:113], v25 offset:52832
    ds_read_b64_tr_b16 a[114:115], v25 offset:53728
    ds_read_b128 v[88:91], v30 offset:40608
    ds_read_b128 v[92:95], v30 offset:40624
    v_fmac_f32 v96, v32, v50
    v_fmac_f32 v112, v32, v51
    v_fmac_f32 v96, v34, v51
    v_fmac_f32 v112, v33, v50
    v_mfma_f32_32x32x16_bf16 a[64:79], a[120:123], v[168:171], a[64:79]
    ds_read_b64_tr_b16 a[116:117], v25 offset:52864
    ds_read_b64_tr_b16 a[118:119], v25 offset:53760
    buffer_load_dwordx4 v15, s[60:63], s98 offen offset:3072 lds
    v_fmac_f32 v97, v32, v96
    v_fmac_f32 v113, v32, v112
    v_fmac_f32 v97, v34, v112
    v_fmac_f32 v113, v33, v96
    v_fmac_f32 v98, v32, v97
    v_mfma_f32_32x32x16_bf16 a[80:95], a[124:127], v[168:171], a[80:95]
    ds_read_b64_tr_b16 a[120:121], v25 offset:52896
    ds_read_b64_tr_b16 a[122:123], v25 offset:53792
    v_fmac_f32 v114, v32, v113
    v_fmac_f32 v98, v34, v113
    v_fmac_f32 v114, v33, v97
    v_fmac_f32 v99, v32, v98
    v_fmac_f32 v115, v32, v114
    v_fmac_f32 v99, v34, v114
    s_waitcnt lgkmcnt(10)
    v_mfma_f32_32x32x16_bf16 a[96:111], a[128:131], v[168:171], a[96:111]
    ds_read_b64_tr_b16 a[124:125], v25 offset:52928
    ds_read_b64_tr_b16 a[126:127], v25 offset:53824
    v_fmac_f32 v115, v33, v98
    v_fmac_f32 v100, v32, v99
    v_fmac_f32 v116, v32, v115
    v_fmac_f32 v100, v34, v115
    v_fmac_f32 v116, v33, v99
    v_mfma_f32_32x32x16_bf16 a[0:15], a[132:135], v[172:175], a[0:15]
    s_waitcnt vmcnt(17)
    s_barrier
    ds_read_b64_tr_b16 a[128:129], v26 offset:0
    ds_read_b64_tr_b16 a[130:131], v26 offset:896
    v_fmac_f32 v101, v32, v100
    v_fmac_f32 v117, v32, v116
    v_fmac_f32 v101, v34, v116
    v_fmac_f32 v117, v33, v100
    v_mfma_f32_32x32x16_bf16 a[16:31], a[136:139], v[172:175], a[16:31]
    ds_read_b64_tr_b16 a[132:133], v26 offset:32
    ds_read_b64_tr_b16 a[134:135], v26 offset:928
    s_add_u32 m0, s93, 0x9000
    s_add_u32 s100, s100, 1
    s_and_b32 s100, s100, 7
    buffer_load_dwordx4 v16, s[60:63], s98 offen offset:0 lds
    v_fmac_f32 v102, v32, v101
    v_fmac_f32 v118, v32, v117
    v_mfma_f32_32x32x16_bf16 a[32:47], a[140:143], v[172:175], a[32:47]
    ds_read_b64_tr_b16 a[136:137], v26 offset:64
    ds_read_b64_tr_b16 a[138:139], v26 offset:960
    v_fmac_f32 v102, v34, v117
    v_fmac_f32 v118, v33, v101
    v_fmac_f32 v103, v32, v102
    v_fmac_f32 v119, v32, v118
    v_fmac_f32 v103, v34, v118
    v_fmac_f32 v119, v33, v102
    s_waitcnt lgkmcnt(6)
    v_mfma_f32_32x32x16_bf16 a[48:63], a[112:115], v[172:175], a[48:63]
    ds_read_b64_tr_b16 a[140:141], v26 offset:96
    ds_read_b64_tr_b16 a[142:143], v26 offset:992
    buffer_store_dwordx4 a[208:211], v31, s[80:83], s26 offen offset:1024 sc1
    v_fmac_f32 v104, v32, v103
    v_fmac_f32 v120, v32, v119
    v_fmac_f32 v104, v34, v119
    v_fmac_f32 v120, v33, v103
    v_mfma_f32_32x32x16_bf16 a[64:79], a[116:119], v[172:175], a[64:79]
    ds_read_b64_tr_b16 a[112:113], v26 offset:128
    ds_read_b64_tr_b16 a[114:115], v26 offset:1024
    v_fmac_f32 v105, v32, v104
    v_fmac_f32 v121, v32, v120
    v_fmac_f32 v105, v34, v120
    v_fmac_f32 v121, v33, v104
    v_fmac_f32 v106, v32, v105
    v_fmac_f32 v122, v32, v121
    v_mfma_f32_32x32x16_bf16 a[80:95], a[120:123], v[172:175], a[80:95]
    ds_read_b64_tr_b16 a[116:117], v26 offset:160
    ds_read_b64_tr_b16 a[118:119], v26 offset:1056
    buffer_load_dwordx4 v17, s[60:63], s98 offen offset:1024 lds
    v_fmac_f32 v106, v34, v121
    v_fmac_f32 v122, v33, v105
    v_fmac_f32 v107, v32, v106
    v_fmac_f32 v123, v32, v122
    v_fmac_f32 v107, v34, v122
    v_mfma_f32_32x32x16_bf16 a[96:111], a[124:127], v[172:175], a[96:111]
    ds_read_b64_tr_b16 a[120:121], v26 offset:192
    ds_read_b64_tr_b16 a[122:123], v26 offset:1088
    v_fmac_f32 v123, v33, v106
    v_fmac_f32 v108, v32, v107
    v_fmac_f32 v124, v32, v123
    v_fmac_f32 v108, v34, v123
    v_fmac_f32 v124, v33, v107
    v_fmac_f32 v109, v32, v108
    s_waitcnt lgkmcnt(6)
    v_mfma_f32_32x32x16_bf16 a[0:15], a[128:131], v[176:179], a[0:15]
    ds_read_b64_tr_b16 a[124:125], v26 offset:3584
    ds_read_b64_tr_b16 a[126:127], v26 offset:4480
    v_fmac_f32 v125, v32, v124
    v_fmac_f32 v109, v34, v124
    v_fmac_f32 v125, v33, v108
    v_fmac_f32 v110, v32, v109
    v_fmac_f32 v126, v32, v125
    v_mfma_f32_32x32x16_bf16 a[16:31], a[132:135], v[176:179], a[16:31]
    ds_read_b64_tr_b16 a[128:129], v26 offset:3616
    ds_read_b64_tr_b16 a[130:131], v26 offset:4512
    v_fmac_f32 v110, v34, v125
    v_fmac_f32 v126, v33, v109
    v_fmac_f32 v111, v32, v110
    v_fmac_f32 v127, v32, v126
    v_fmac_f32 v111, v34, v126
    v_fmac_f32 v127, v33, v110
    v_mfma_f32_32x32x16_bf16 a[32:47], a[136:139], v[176:179], a[32:47]
    ds_read_b64_tr_b16 a[132:133], v26 offset:3648
    ds_read_b64_tr_b16 a[134:135], v26 offset:4544
    buffer_load_dwordx4 v18, s[60:63], s98 offen offset:2048 lds
    s_waitcnt lgkmcnt(15)
    v_mul_f32 v96, v96, v80
    v_mul_f32 v112, v112, v80
    v_mul_f32 v97, v97, v81
    v_mul_f32 v113, v113, v81
    v_mfma_f32_32x32x16_bf16 a[48:63], a[140:143], v[176:179], a[48:63]
    ds_read_b64_tr_b16 a[136:137], v26 offset:3680
    ds_read_b64_tr_b16 a[138:139], v26 offset:4576
    v_mul_f32 v98, v98, v82
    v_mul_f32 v114, v114, v82
    v_mul_f32 v99, v99, v83
    v_mul_f32 v115, v115, v83
    v_mul_f32 v100, v100, v84
    v_mul_f32 v116, v116, v84
    s_waitcnt lgkmcnt(6)
    v_mfma_f32_32x32x16_bf16 a[64:79], a[112:115], v[176:179], a[64:79]
    ds_read_b64_tr_b16 a[140:141], v26 offset:3712
    ds_read_b64_tr_b16 a[142:143], v26 offset:4608
    buffer_store_dwordx4 a[208:211], v31, s[80:83], s27 offen offset:0 sc1
    v_mul_f32 v101, v101, v85
    v_mul_f32 v117, v117, v85
    v_mul_f32 v102, v102, v86
    v_mul_f32 v118, v118, v86
    v_mfma_f32_32x32x16_bf16 a[80:95], a[116:119], v[176:179], a[80:95]
    ds_read_b64_tr_b16 a[112:113], v26 offset:3744
    ds_read_b64_tr_b16 a[114:115], v26 offset:4640
    v_mul_f32 v103, v103, v87
    v_mul_f32 v119, v119, v87
    v_mul_f32 v104, v104, v88
    v_mul_f32 v120, v120, v88
    v_mul_f32 v105, v105, v89
    v_mul_f32 v121, v121, v89
    v_mfma_f32_32x32x16_bf16 a[96:111], a[120:123], v[176:179], a[96:111]
    ds_read_b64_tr_b16 a[116:117], v26 offset:3776
    ds_read_b64_tr_b16 a[118:119], v26 offset:4672
    s_add_u32 m0, s93, 0x10000
    s_mul_i32 s98, s100, 229376
    s_add_u32 s98, s98, s89
    buffer_load_dwordx4 v12, s[60:63], s98 offen offset:0 lds
    v_mul_f32 v106, v106, v90
    v_mul_f32 v122, v122, v90
    v_mfma_f32_32x32x16_bf16 a[0:15], a[124:127], v[180:183], a[0:15]
    ds_read_b64_tr_b16 a[120:121], v26 offset:16384
    ds_read_b64_tr_b16 a[122:123], v26 offset:17280
    v_mul_f32 v107, v107, v91
    v_mul_f32 v123, v123, v91
    v_mul_f32 v108, v108, v92
    v_mul_f32 v124, v124, v92
    v_mul_f32 v109, v109, v93
    v_mul_f32 v125, v125, v93
    s_waitcnt lgkmcnt(6)
    v_mfma_f32_32x32x16_bf16 a[16:31], a[128:131], v[180:183], a[16:31]
    ds_read_b64_tr_b16 a[124:125], v26 offset:16416
    ds_read_b64_tr_b16 a[126:127], v26 offset:17312
    v_mul_f32 v110, v110, v94
    v_mul_f32 v126, v126, v94
    v_mul_f32 v111, v111, v95
    v_mul_f32 v127, v127, v95
    v_cvt_pk_bf16_f32 v72, v96, v97
    v_mfma_f32_32x32x16_bf16 a[32:47], a[132:135], v[180:183], a[32:47]
    ds_read_b64_tr_b16 a[128:129], v26 offset:16448
    ds_read_b64_tr_b16 a[130:131], v26 offset:17344
    v_cvt_pk_bf16_f32 v80, -v112, -v113
    v_cvt_pk_bf16_f32 v73, v98, v99
    v_cvt_pk_bf16_f32 v81, -v114, -v115
    v_cvt_pk_bf16_f32 v74, v100, v101
    v_cvt_pk_bf16_f32 v82, -v116, -v117
    v_cvt_pk_bf16_f32 v75, v102, v103
    v_mfma_f32_32x32x16_bf16 a[48:63], a[136:139], v[180:183], a[48:63]
    ds_read_b64_tr_b16 a[132:133], v26 offset:16480
    ds_read_b64_tr_b16 a[134:135], v26 offset:17376
    buffer_load_dwordx4 v13, s[60:63], s98 offen offset:1024 lds
    v_cvt_pk_bf16_f32 v83, -v118, -v119
    v_cvt_pk_bf16_f32 v76, v104, v105
    v_cvt_pk_bf16_f32 v84, -v120, -v121
    v_cvt_pk_bf16_f32 v77, v106, v107
    v_cvt_pk_bf16_f32 v85, -v122, -v123
    v_mfma_f32_32x32x16_bf16 a[64:79], a[140:143], v[180:183], a[64:79]
    ds_read_b64_tr_b16 a[136:137], v26 offset:16512
    ds_read_b64_tr_b16 a[138:139], v26 offset:17408
    v_cvt_pk_bf16_f32 v78, v108, v109
    v_cvt_pk_bf16_f32 v86, -v124, -v125
    v_cvt_pk_bf16_f32 v79, v110, v111
    v_cvt_pk_bf16_f32 v87, -v126, -v127
    v_bfe_u32 v65, v1, 2, 2
    v_lshl_add_u32 v65, v2, 3, v65
    s_waitcnt lgkmcnt(6)
    v_mfma_f32_32x32x16_bf16 a[80:95], a[112:115], v[180:183], a[80:95]
    ds_read_b64_tr_b16 a[140:141], v26 offset:16544
    ds_read_b64_tr_b16 a[142:143], v26 offset:17440
    buffer_store_dwordx4 a[208:211], v31, s[80:83], s27 offen offset:1024 sc1
    v_lshlrev_b32 v65, 6, v65
    v_and_b32 v67, 1, v1
    v_lshl_add_u32 v65, v67, 5, v65
    v_bfe_u32 v67, v1, 1, 1
    v_mfma_f32_32x32x16_bf16 a[96:111], a[116:119], v[180:183], a[96:111]
    ds_read_b64_tr_b16 a[112:113], v26 offset:16576
    ds_read_b64_tr_b16 a[114:115], v26 offset:17472
    v_lshl_add_u32 v65, v67, 3, v65
    v_bfe_u32 v67, v1, 4, 1
    v_bfe_u32 v64, v1, 3, 1
    v_xor_b32 v67, v67, v64
    v_lshl_add_u32 v65, v67, 4, v65
    s_add_u32 s99, s13, 0x18000
    v_add_u32 v66, s99, v66
    v_add_u32 v65, s99, v65
    v_mfma_f32_32x32x16_bf16 a[0:15], a[120:123], v[184:187], a[0:15]
    ds_read_b64_tr_b16 a[116:117], v26 offset:19968
    ds_read_b64_tr_b16 a[118:119], v26 offset:20864
    buffer_load_dwordx4 v14, s[60:63], s98 offen offset:2048 lds
    v_xor_b32 v67, 16, v66
    v_xor_b32 v64, 32, v65
    v_mfma_f32_32x32x16_bf16 a[16:31], a[124:127], v[184:187], a[16:31]
    ds_read_b64_tr_b16 a[120:121], v26 offset:20000
    ds_read_b64_tr_b16 a[122:123], v26 offset:20896
    s_waitcnt lgkmcnt(6)
    v_mfma_f32_32x32x16_bf16 a[32:47], a[128:131], v[184:187], a[32:47]
    ds_read_b64_tr_b16 a[124:125], v26 offset:20032
    ds_read_b64_tr_b16 a[126:127], v26 offset:20928
    v_mfma_f32_32x32x16_bf16 a[48:63], a[132:135], v[184:187], a[48:63]
    ds_read_b64_tr_b16 a[128:129], v26 offset:20064
    ds_read_b64_tr_b16 a[130:131], v26 offset:20960
    v_mfma_f32_32x32x16_bf16 a[64:79], a[136:139], v[184:187], a[64:79]
    ds_read_b64_tr_b16 a[132:133], v26 offset:20096
    ds_read_b64_tr_b16 a[134:135], v26 offset:20992
    buffer_load_dwordx4 v15, s[60:63], s98 offen offset:3072 lds
    v_mfma_f32_32x32x16_bf16 a[80:95], a[140:143], v[184:187], a[80:95]
    ds_read_b64_tr_b16 a[136:137], v26 offset:20128
    ds_read_b64_tr_b16 a[138:139], v26 offset:21024
    s_waitcnt lgkmcnt(6)
    v_mfma_f32_32x32x16_bf16 a[96:111], a[112:115], v[184:187], a[96:111]
    ds_read_b64_tr_b16 a[140:141], v26 offset:20160
    ds_read_b64_tr_b16 a[142:143], v26 offset:21056
    v_mfma_f32_32x32x16_bf16 a[0:15], a[116:119], v[188:191], a[0:15]
    s_waitcnt vmcnt(16)
    s_barrier
    ds_read_b64_tr_b16 a[112:113], v24 offset:0
    ds_read_b64_tr_b16 a[114:115], v24 offset:896
    ds_write_b128 v66, v[72:75] offset:0
    ds_write_b128 v67, v[76:79] offset:0
    ds_write_b128 v66, v[80:83] offset:2048
    ds_write_b128 v67, v[84:87] offset:2048
    v_mfma_f32_32x32x16_bf16 a[16:31], a[120:123], v[188:191], a[16:31]
    ds_read_b64_tr_b16 a[116:117], v24 offset:32
    ds_read_b64_tr_b16 a[118:119], v24 offset:928
    s_add_u32 m0, s93, 0x11000
    s_add_u32 s100, s100, 1
    s_and_b32 s100, s100, 7
    buffer_load_dwordx4 v16, s[60:63], s98 offen offset:0 lds
    ds_read_b64_tr_b16 a[144:145], v65 offset:0
    ds_read_b64_tr_b16 a[146:147], v64 offset:256
    v_mfma_f32_32x32x16_bf16 a[32:47], a[124:127], v[188:191], a[32:47]
    ds_read_b64_tr_b16 a[120:121], v24 offset:64
    ds_read_b64_tr_b16 a[122:123], v24 offset:960
    ds_read_b64_tr_b16 a[148:149], v65 offset:1024
    ds_read_b64_tr_b16 a[150:151], v64 offset:1280
    ds_read_b64_tr_b16 a[152:153], v65 offset:2048
    ds_read_b64_tr_b16 a[154:155], v64 offset:2304
    s_waitcnt lgkmcnt(15)
    v_mfma_f32_32x32x16_bf16 a[48:63], a[128:131], v[188:191], a[48:63]
    ds_read_b64_tr_b16 a[124:125], v24 offset:96
    ds_read_b64_tr_b16 a[126:127], v24 offset:992
    ds_read_b64_tr_b16 a[156:157], v65 offset:3072
    ds_read_b64_tr_b16 a[158:159], v64 offset:3328
    v_mfma_f32_32x32x16_bf16 a[64:79], a[132:135], v[188:191], a[64:79]
    ds_read_b64_tr_b16 a[128:129], v24 offset:128
    ds_read_b64_tr_b16 a[130:131], v24 offset:1024
    v_mfma_f32_32x32x16_bf16 a[80:95], a[136:139], v[188:191], a[80:95]
    ds_read_b64_tr_b16 a[132:133], v24 offset:160
    ds_read_b64_tr_b16 a[134:135], v24 offset:1056
    buffer_load_dwordx4 v17, s[60:63], s98 offen offset:1024 lds
    v_mfma_f32_32x32x16_bf16 a[96:111], a[140:143], v[188:191], a[96:111]
    ds_read_b64_tr_b16 a[136:137], v24 offset:192
    ds_read_b64_tr_b16 a[138:139], v24 offset:1088
    s_waitcnt lgkmcnt(6)
    v_and_b32 v66, 31, v1
    v_lshlrev_b32 v90, 1, v66
    v_lshlrev_b32 v66, 2, v66
    s_waitcnt lgkmcnt(8)
    v_mfma_f32_32x32x16_bf16 a[0:15], a[112:115], v[192:195], a[0:15]
    ds_read_b64_tr_b16 a[140:141], v24 offset:3584
    ds_read_b64_tr_b16 a[142:143], v24 offset:4480
    buffer_store_dwordx4 a[144:147], v31, s[80:83], s90 offen offset:0 sc1
    v_lshl_add_u32 v92, v2, 15, v66
    v_lshrrev_b32 v66, 2, v1
    v_mfma_f32_32x32x16_bf16 a[16:31], a[116:119], v[192:195], a[16:31]
    ds_read_b64_tr_b16 a[112:113], v24 offset:3616
    ds_read_b64_tr_b16 a[114:115], v24 offset:4512
    v_and_b32 v67, 3, v1
    v_lshlrev_b32 v64, 4, v67
    v_lshl_add_u32 v91, v66, 10, v64
    v_and_b32 v66, 3, v66
    v_mfma_f32_32x32x16_bf16 a[32:47], a[120:123], v[192:195], a[32:47]
    ds_read_b64_tr_b16 a[116:117], v24 offset:3648
    ds_read_b64_tr_b16 a[118:119], v24 offset:4544
    buffer_load_dwordx4 v18, s[60:63], s98 offen offset:2048 lds
    v_lshl_add_u32 v66, v2, 4, v66
    v_lshlrev_b32 v66, 6, v66
    v_lshl_add_u32 v66, v67, 3, v66
    v_mfma_f32_32x32x16_bf16 a[48:63], a[124:127], v[192:195], a[48:63]
    ds_read_b64_tr_b16 a[120:121], v24 offset:3680
    ds_read_b64_tr_b16 a[122:123], v24 offset:4576
    v_bfe_u32 v67, v1, 4, 1
    v_lshl_add_u32 v66, v67, 5, v66
    s_lshl_b32 s99, s3, 14
    s_add_u32 s99, s99, 0x13800
    v_add_u32 v87, s99, v66
    s_waitcnt lgkmcnt(6)
    v_mfma_f32_32x32x16_bf16 a[64:79], a[128:131], v[192:195], a[64:79]
    ds_read_b64_tr_b16 a[124:125], v24 offset:3712
    ds_read_b64_tr_b16 a[126:127], v24 offset:4608
    buffer_store_dwordx4 a[148:151], v31, s[80:83], s90 offen offset:1024 sc1
    global_load_ushort v93, v90, s[32:33]
    v_mfma_f32_32x32x16_bf16 a[80:95], a[132:135], v[192:195], a[80:95]
    ds_read_b64_tr_b16 a[128:129], v24 offset:3744
    ds_read_b64_tr_b16 a[130:131], v24 offset:4640
    v_mfma_f32_32x32x16_bf16 a[96:111], a[136:139], v[192:195], a[96:111]
    ds_read_b64_tr_b16 a[132:133], v24 offset:3776
    ds_read_b64_tr_b16 a[134:135], v24 offset:4672
    s_add_u32 m0, s93, 0x18000
    s_mul_i32 s98, s100, 229376
    s_add_u32 s98, s98, s89
    buffer_load_dwordx4 v12, s[60:63], s98 offen offset:0 lds
    v_mfma_f32_32x32x16_bf16 a[0:15], a[140:143], v[196:199], a[0:15]
    ds_read_b64_tr_b16 a[136:137], v24 offset:16384
    ds_read_b64_tr_b16 a[138:139], v24 offset:17280
    s_waitcnt lgkmcnt(6)
    v_mfma_f32_32x32x16_bf16 a[16:31], a[112:115], v[196:199], a[16:31]
    ds_read_b64_tr_b16 a[140:141], v24 offset:16416
    ds_read_b64_tr_b16 a[142:143], v24 offset:17312
    buffer_store_dwordx4 a[152:155], v31, s[80:83], s90 offen offset:2048 sc1
    v_mfma_f32_32x32x16_bf16 a[32:47], a[116:119], v[196:199], a[32:47]
    ds_read_b64_tr_b16 a[112:113], v24 offset:16448
    ds_read_b64_tr_b16 a[114:115], v24 offset:17344
    v_mfma_f32_32x32x16_bf16 a[48:63], a[120:123], v[196:199], a[48:63]
    ds_read_b64_tr_b16 a[116:117], v24 offset:16480
    ds_read_b64_tr_b16 a[118:119], v24 offset:17376
    buffer_load_dwordx4 v13, s[60:63], s98 offen offset:1024 lds
    v_mfma_f32_32x32x16_bf16 a[64:79], a[124:127], v[196:199], a[64:79]
    ds_read_b64_tr_b16 a[120:121], v24 offset:16512
    ds_read_b64_tr_b16 a[122:123], v24 offset:17408
    s_waitcnt lgkmcnt(6)
    v_mfma_f32_32x32x16_bf16 a[80:95], a[128:131], v[196:199], a[80:95]
    ds_read_b64_tr_b16 a[124:125], v24 offset:16544
    ds_read_b64_tr_b16 a[126:127], v24 offset:17440
    buffer_store_dwordx4 a[156:159], v31, s[80:83], s90 offen offset:3072 sc1
    v_mfma_f32_32x32x16_bf16 a[96:111], a[132:135], v[196:199], a[96:111]
    ds_read_b64_tr_b16 a[128:129], v24 offset:16576
    ds_read_b64_tr_b16 a[130:131], v24 offset:17472
    v_mfma_f32_32x32x16_bf16 a[0:15], a[136:139], v[200:203], a[0:15]
    ds_read_b64_tr_b16 a[132:133], v24 offset:19968
    ds_read_b64_tr_b16 a[134:135], v24 offset:20864
    buffer_load_dwordx4 v14, s[60:63], s98 offen offset:2048 lds
    v_mfma_f32_32x32x16_bf16 a[16:31], a[140:143], v[200:203], a[16:31]
    ds_read_b64_tr_b16 a[136:137], v24 offset:20000
    ds_read_b64_tr_b16 a[138:139], v24 offset:20896
    s_waitcnt lgkmcnt(6)
    v_mfma_f32_32x32x16_bf16 a[32:47], a[112:115], v[200:203], a[32:47]
    ds_read_b64_tr_b16 a[140:141], v24 offset:20032
    ds_read_b64_tr_b16 a[142:143], v24 offset:20928
    v_mfma_f32_32x32x16_bf16 a[48:63], a[116:119], v[200:203], a[48:63]
    ds_read_b64_tr_b16 a[112:113], v24 offset:20064
    ds_read_b64_tr_b16 a[114:115], v24 offset:20960
    v_mfma_f32_32x32x16_bf16 a[64:79], a[120:123], v[200:203], a[64:79]
    ds_read_b64_tr_b16 a[116:117], v24 offset:20096
    ds_read_b64_tr_b16 a[118:119], v24 offset:20992
    buffer_load_dwordx4 v15, s[60:63], s98 offen offset:3072 lds
    v_mfma_f32_32x32x16_bf16 a[80:95], a[124:127], v[200:203], a[80:95]
    ds_read_b64_tr_b16 a[120:121], v24 offset:20128
    ds_read_b64_tr_b16 a[122:123], v24 offset:21024
    s_waitcnt lgkmcnt(6)
    v_mfma_f32_32x32x16_bf16 a[96:111], a[128:131], v[200:203], a[96:111]
    ds_read_b64_tr_b16 a[124:125], v24 offset:20160
    ds_read_b64_tr_b16 a[126:127], v24 offset:21056
    v_mfma_f32_32x32x16_bf16 a[0:15], a[132:135], v[204:207], a[0:15]
    s_waitcnt vmcnt(18)
    s_barrier
    ds_read_b64_tr_b16 a[128:129], v24 offset:32768
    ds_read_b64_tr_b16 a[130:131], v24 offset:33664
    v_mfma_f32_32x32x16_bf16 a[16:31], a[136:139], v[204:207], a[16:31]
    ds_read_b64_tr_b16 a[132:133], v24 offset:32800
    ds_read_b64_tr_b16 a[134:135], v24 offset:33696
    s_add_u32 m0, s93, 0x19000
    s_add_u32 s100, s100, 1
    s_and_b32 s100, s100, 7
    buffer_load_dwordx4 v16, s[60:63], s98 offen offset:0 lds
    v_mfma_f32_32x32x16_bf16 a[32:47], a[140:143], v[204:207], a[32:47]
    ds_read_b64_tr_b16 a[136:137], v24 offset:32832
    ds_read_b64_tr_b16 a[138:139], v24 offset:33728
    s_waitcnt lgkmcnt(6)
    v_mfma_f32_32x32x16_bf16 a[48:63], a[112:115], v[204:207], a[48:63]
    ds_read_b64_tr_b16 a[140:141], v24 offset:32864
    ds_read_b64_tr_b16 a[142:143], v24 offset:33760
    v_mfma_f32_32x32x16_bf16 a[64:79], a[116:119], v[204:207], a[64:79]
    ds_read_b64_tr_b16 a[112:113], v24 offset:32896
    ds_read_b64_tr_b16 a[114:115], v24 offset:33792
    v_mfma_f32_32x32x16_bf16 a[80:95], a[120:123], v[204:207], a[80:95]
    ds_read_b64_tr_b16 a[116:117], v24 offset:32928
    ds_read_b64_tr_b16 a[118:119], v24 offset:33824
    buffer_load_dwordx4 v17, s[60:63], s98 offen offset:1024 lds
    v_mfma_f32_32x32x16_bf16 a[96:111], a[124:127], v[204:207], a[96:111]
    ds_read_b64_tr_b16 a[120:121], v24 offset:32960
    ds_read_b64_tr_b16 a[122:123], v24 offset:33856
    s_waitcnt lgkmcnt(6)
    v_mfma_f32_32x32x16_bf16 a[0:15], a[128:131], v[208:211], a[0:15]
    ds_read_b64_tr_b16 a[124:125], v24 offset:36352
    ds_read_b64_tr_b16 a[126:127], v24 offset:37248
    v_mfma_f32_32x32x16_bf16 a[16:31], a[132:135], v[208:211], a[16:31]
    ds_read_b64_tr_b16 a[128:129], v24 offset:36384
    ds_read_b64_tr_b16 a[130:131], v24 offset:37280
    v_mfma_f32_32x32x16_bf16 a[32:47], a[136:139], v[208:211], a[32:47]
    ds_read_b64_tr_b16 a[132:133], v24 offset:36416
    ds_read_b64_tr_b16 a[134:135], v24 offset:37312
    buffer_load_dwordx4 v18, s[60:63], s98 offen offset:2048 lds
    v_mfma_f32_32x32x16_bf16 a[48:63], a[140:143], v[208:211], a[48:63]
    ds_read_b64_tr_b16 a[136:137], v24 offset:36448
    ds_read_b64_tr_b16 a[138:139], v24 offset:37344
    s_waitcnt lgkmcnt(6)
    v_mfma_f32_32x32x16_bf16 a[64:79], a[112:115], v[208:211], a[64:79]
    ds_read_b64_tr_b16 a[140:141], v24 offset:36480
    ds_read_b64_tr_b16 a[142:143], v24 offset:37376
    v_mfma_f32_32x32x16_bf16 a[80:95], a[116:119], v[208:211], a[80:95]
    ds_read_b64_tr_b16 a[112:113], v24 offset:36512
    ds_read_b64_tr_b16 a[114:115], v24 offset:37408
    v_mov_b32 v19, s41
    s_waitcnt vmcnt(5)
    buffer_store_dwordx4 v[18:21], v3, s[80:83], 0 offen sc1
    s_add_u32 m0, s13, 0x20000
    s_xor_b32 s98, s91, 0
    buffer_load_dwordx4 v4, s[64:67], s98 offen offset:0 lds
    v_mfma_f32_32x32x16_bf16 a[96:111], a[120:123], v[208:211], a[96:111]
    ds_read_b64_tr_b16 a[116:117], v24 offset:36544
    ds_read_b64_tr_b16 a[118:119], v24 offset:37440
    v_mfma_f32_32x32x16_bf16 a[0:15], a[124:127], v[212:215], a[0:15]
    ds_read_b64_tr_b16 a[120:121], v24 offset:49152
    ds_read_b64_tr_b16 a[122:123], v24 offset:50048
    s_waitcnt lgkmcnt(6)
    v_mfma_f32_32x32x16_bf16 a[16:31], a[128:131], v[212:215], a[16:31]
    ds_read_b64_tr_b16 a[124:125], v24 offset:49184
    ds_read_b64_tr_b16 a[126:127], v24 offset:50080
    buffer_load_dwordx4 v5, s[64:67], s98 offen offset:1024 lds
    v_mfma_f32_32x32x16_bf16 a[32:47], a[132:135], v[212:215], a[32:47]
    ds_read_b64_tr_b16 a[128:129], v24 offset:49216
    ds_read_b64_tr_b16 a[130:131], v24 offset:50112
    v_mfma_f32_32x32x16_bf16 a[48:63], a[136:139], v[212:215], a[48:63]
    ds_read_b64_tr_b16 a[132:133], v24 offset:49248
    ds_read_b64_tr_b16 a[134:135], v24 offset:50144
    v_mfma_f32_32x32x16_bf16 a[64:79], a[140:143], v[212:215], a[64:79]
    ds_read_b64_tr_b16 a[136:137], v24 offset:49280
    ds_read_b64_tr_b16 a[138:139], v24 offset:50176
    buffer_load_dwordx4 v6, s[64:67], s98 offen offset:2048 lds
    s_waitcnt lgkmcnt(6)
    v_mfma_f32_32x32x16_bf16 a[80:95], a[112:115], v[212:215], a[80:95]
    ds_read_b64_tr_b16 a[140:141], v24 offset:49312
    ds_read_b64_tr_b16 a[142:143], v24 offset:50208
    v_mfma_f32_32x32x16_bf16 a[96:111], a[116:119], v[212:215], a[96:111]
    ds_read_b64_tr_b16 a[112:113], v24 offset:49344
    ds_read_b64_tr_b16 a[114:115], v24 offset:50240
    v_mfma_f32_32x32x16_bf16 a[0:15], a[120:123], v[216:219], a[0:15]
    ds_read_b64_tr_b16 a[116:117], v24 offset:52736
    ds_read_b64_tr_b16 a[118:119], v24 offset:53632
    buffer_load_dwordx4 v7, s[64:67], s98 offen offset:3072 lds
    v_mfma_f32_32x32x16_bf16 a[16:31], a[124:127], v[216:219], a[16:31]
    ds_read_b64_tr_b16 a[120:121], v24 offset:52768
    ds_read_b64_tr_b16 a[122:123], v24 offset:53664
    s_waitcnt lgkmcnt(6)
    v_mfma_f32_32x32x16_bf16 a[32:47], a[128:131], v[216:219], a[32:47]
    ds_read_b64_tr_b16 a[124:125], v24 offset:52800
    ds_read_b64_tr_b16 a[126:127], v24 offset:53696
    v_mfma_f32_32x32x16_bf16 a[48:63], a[132:135], v[216:219], a[48:63]
    ds_read_b64_tr_b16 a[128:129], v24 offset:52832
    ds_read_b64_tr_b16 a[130:131], v24 offset:53728
    s_add_u32 m0, s13, 0x21000
    s_xor_b32 s98, s91, 128
    buffer_load_dwordx4 v4, s[64:67], s98 offen offset:0 lds
    v_mfma_f32_32x32x16_bf16 a[64:79], a[136:139], v[216:219], a[64:79]
    ds_read_b64_tr_b16 a[132:133], v24 offset:52864
    ds_read_b64_tr_b16 a[134:135], v24 offset:53760
    v_mfma_f32_32x32x16_bf16 a[80:95], a[140:143], v[216:219], a[80:95]
    ds_read_b64_tr_b16 a[136:137], v24 offset:52896
    ds_read_b64_tr_b16 a[138:139], v24 offset:53792
    s_waitcnt lgkmcnt(6)
    v_mfma_f32_32x32x16_bf16 a[96:111], a[112:115], v[216:219], a[96:111]
    ds_read_b64_tr_b16 a[140:141], v24 offset:52928
    ds_read_b64_tr_b16 a[142:143], v24 offset:53824
    buffer_load_dwordx4 v5, s[64:67], s98 offen offset:1024 lds
    v_mfma_f32_32x32x16_bf16 a[0:15], a[116:119], v[220:223], a[0:15]
    s_waitcnt vmcnt(7)
    s_barrier
    ds_read_b64_tr_b16 a[112:113], v25 offset:0
    ds_read_b64_tr_b16 a[114:115], v25 offset:896
    v_mfma_f32_32x32x16_bf16 a[16:31], a[120:123], v[220:223], a[16:31]
    ds_read_b64_tr_b16 a[116:117], v25 offset:3584
    ds_read_b64_tr_b16 a[118:119], v25 offset:4480
    v_mfma_f32_32x32x16_bf16 a[32:47], a[124:127], v[220:223], a[32:47]
    ds_read_b64_tr_b16 a[120:121], v25 offset:16384
    ds_read_b64_tr_b16 a[122:123], v25 offset:17280
    buffer_load_dwordx4 v6, s[64:67], s98 offen offset:2048 lds
    s_waitcnt lgkmcnt(6)
    v_mfma_f32_32x32x16_bf16 a[48:63], a[128:131], v[220:223], a[48:63]
    ds_read_b64_tr_b16 a[124:125], v25 offset:19968
    ds_read_b64_tr_b16 a[126:127], v25 offset:20864
    v_mfma_f32_32x32x16_bf16 a[64:79], a[132:135], v[220:223], a[64:79]
    ds_read_b64_tr_b16 a[128:129], v25 offset:32768
    ds_read_b64_tr_b16 a[130:131], v25 offset:33664
    v_mfma_f32_32x32x16_bf16 a[80:95], a[136:139], v[220:223], a[80:95]
    ds_read_b64_tr_b16 a[132:133], v25 offset:36352
    ds_read_b64_tr_b16 a[134:135], v25 offset:37248
    buffer_load_dwordx4 v7, s[64:67], s98 offen offset:3072 lds
    v_mfma_f32_32x32x16_bf16 a[96:111], a[140:143], v[220:223], a[96:111]
    ds_read_b64_tr_b16 a[136:137], v25 offset:49152
    ds_read_b64_tr_b16 a[138:139], v25 offset:50048
    s_waitcnt lgkmcnt(6)
    v_mfma_f32_32x32x16_bf16 a[0:15], a[112:115], v[224:227], a[0:15]
    ds_read_b64_tr_b16 a[140:141], v25 offset:52736
    ds_read_b64_tr_b16 a[142:143], v25 offset:53632
    s_add_u32 m0, s13, 0x0
    s_xor_b32 s98, s91, 0
    buffer_load_dwordx4 v4, s[68:71], s98 offen offset:0 lds
    v_mfma_f32_32x32x16_bf16 a[0:15], a[116:119], v[228:231], a[0:15]
    ds_read_b64_tr_b16 a[112:113], v25 offset:32
    ds_read_b64_tr_b16 a[114:115], v25 offset:928
    v_mfma_f32_32x32x16_bf16 a[0:15], a[120:123], v[232:235], a[0:15]
    ds_read_b64_tr_b16 a[116:117], v25 offset:3616
    ds_read_b64_tr_b16 a[118:119], v25 offset:4512
    buffer_load_dwordx4 v5, s[68:71], s98 offen offset:1024 lds
    v_mfma_f32_32x32x16_bf16 a[0:15], a[124:127], v[236:239], a[0:15]
    ds_read_b64_tr_b16 a[120:121], v25 offset:16416
    ds_read_b64_tr_b16 a[122:123], v25 offset:17312
    s_waitcnt lgkmcnt(6)
    v_mfma_f32_32x32x16_bf16 a[0:15], a[128:131], v[240:243], a[0:15]
    s_barrier
    ds_read_b64_tr_b16 a[124:125], v25 offset:20000
    ds_read_b64_tr_b16 a[126:127], v25 offset:20896
    s_mov_b64 exec, 31
    buffer_load_dword v94, v35, s[80:83], 0 offen offset:4 sc1
    s_mov_b64 exec, -1
    buffer_load_dwordx4 v6, s[68:71], s98 offen offset:2048 lds
    v_mfma_f32_32x32x16_bf16 a[0:15], a[132:135], v[244:247], a[0:15]
    ds_read_b64_tr_b16 a[128:129], v25 offset:32800
    ds_read_b64_tr_b16 a[130:131], v25 offset:33696
    v_mfma_f32_32x32x16_bf16 a[0:15], a[136:139], v[248:251], a[0:15]
    ds_read_b64_tr_b16 a[132:133], v25 offset:36384
    ds_read_b64_tr_b16 a[134:135], v25 offset:37280
    buffer_load_dwordx4 v7, s[68:71], s98 offen offset:3072 lds
    v_mfma_f32_32x32x16_bf16 a[0:15], a[140:143], v[252:255], a[0:15]
    ds_read_b64_tr_b16 a[136:137], v25 offset:49184
    ds_read_b64_tr_b16 a[138:139], v25 offset:50080
    s_waitcnt lgkmcnt(6)
    v_mfma_f32_32x32x16_bf16 a[16:31], a[112:115], v[224:227], a[16:31]
    ds_read_b64_tr_b16 a[140:141], v25 offset:52768
    ds_read_b64_tr_b16 a[142:143], v25 offset:53664
    s_add_u32 m0, s13, 0x1000
    s_xor_b32 s98, s91, 128
    buffer_load_dwordx4 v4, s[68:71], s98 offen offset:0 lds
    v_mfma_f32_32x32x16_bf16 a[16:31], a[116:119], v[228:231], a[16:31]
    ds_read_b64_tr_b16 a[112:113], v25 offset:64
    ds_read_b64_tr_b16 a[114:115], v25 offset:960
    v_mfma_f32_32x32x16_bf16 a[16:31], a[120:123], v[232:235], a[16:31]
    ds_read_b64_tr_b16 a[116:117], v25 offset:3648
    ds_read_b64_tr_b16 a[118:119], v25 offset:4544
    buffer_load_dwordx4 v5, s[68:71], s98 offen offset:1024 lds
    v_accvgpr_read_b32 v96, a0
    v_accvgpr_read_b32 v97, a1
    v_accvgpr_read_b32 v98, a2
    v_mfma_f32_32x32x16_bf16 a[16:31], a[124:127], v[236:239], a[16:31]
    ds_read_b64_tr_b16 a[120:121], v25 offset:16448
    ds_read_b64_tr_b16 a[122:123], v25 offset:17344
    v_accvgpr_read_b32 v99, a3
    v_accvgpr_read_b32 v100, a4
    v_accvgpr_read_b32 v101, a5
    v_accvgpr_read_b32 v102, a6
    s_waitcnt lgkmcnt(6)
    v_mfma_f32_32x32x16_bf16 a[16:31], a[128:131], v[240:243], a[16:31]
    ds_read_b64_tr_b16 a[124:125], v25 offset:20032
    ds_read_b64_tr_b16 a[126:127], v25 offset:20928
    buffer_load_dwordx4 v6, s[68:71], s98 offen offset:2048 lds
    v_accvgpr_read_b32 v103, a7
    v_accvgpr_read_b32 v104, a8
    v_mfma_f32_32x32x16_bf16 a[16:31], a[132:135], v[244:247], a[16:31]
    ds_read_b64_tr_b16 a[128:129], v25 offset:32832
    ds_read_b64_tr_b16 a[130:131], v25 offset:33728
    v_accvgpr_read_b32 v105, a9
    v_accvgpr_read_b32 v106, a10
    v_accvgpr_read_b32 v107, a11
    v_accvgpr_read_b32 v108, a12
    v_mfma_f32_32x32x16_bf16 a[16:31], a[136:139], v[248:251], a[16:31]
    ds_read_b64_tr_b16 a[132:133], v25 offset:36416
    ds_read_b64_tr_b16 a[134:135], v25 offset:37312
    buffer_load_dwordx4 v7, s[68:71], s98 offen offset:3072 lds
    v_accvgpr_read_b32 v109, a13
    v_accvgpr_read_b32 v110, a14
    v_accvgpr_read_b32 v111, a15
    v_mfma_f32_32x32x16_bf16 a[16:31], a[140:143], v[252:255], a[16:31]
    ds_read_b64_tr_b16 a[136:137], v25 offset:49216
    ds_read_b64_tr_b16 a[138:139], v25 offset:50112
    v_mul_f32 v96, v96, v104
    v_mul_f32 v97, v97, v105
    v_mul_f32 v98, v98, v106
    v_mul_f32 v99, v99, v107
    s_waitcnt lgkmcnt(6)
    v_mfma_f32_32x32x16_bf16 a[32:47], a[112:115], v[224:227], a[32:47]
    ds_read_b64_tr_b16 a[140:141], v25 offset:52800
    ds_read_b64_tr_b16 a[142:143], v25 offset:53696
    s_add_u32 m0, s101, 0x8000
    s_add_u32 s98, s37, 0
    buffer_load_dwordx4 v8, s[72:75], s98 offen offset:0 lds
    v_mfma_f32_32x32x16_bf16 a[32:47], a[116:119], v[228:231], a[32:47]
    ds_read_b64_tr_b16 a[112:113], v25 offset:96
    ds_read_b64_tr_b16 a[114:115], v25 offset:992
    v_mul_f32 v100, v100, v108
    v_mul_f32 v101, v101, v109
    v_mul_f32 v102, v102, v110
    v_mul_f32 v103, v103, v111
    v_mfma_f32_32x32x16_bf16 a[32:47], a[120:123], v[232:235], a[32:47]
    ds_read_b64_tr_b16 a[116:117], v25 offset:3680
    ds_read_b64_tr_b16 a[118:119], v25 offset:4576
    buffer_load_dwordx4 v9, s[72:75], s98 offen offset:1024 lds
    v_cvt_pk_bf16_f32 v192, v96, v97
    v_cvt_pk_bf16_f32 v193, v98, v99
    v_cvt_pk_bf16_f32 v194, v100, v101
    v_mfma_f32_32x32x16_bf16 a[32:47], a[124:127], v[236:239], a[32:47]
    ds_read_b64_tr_b16 a[120:121], v25 offset:16480
    ds_read_b64_tr_b16 a[122:123], v25 offset:17376
    v_cvt_pk_bf16_f32 v195, v102, v103
    v_min_u32 v192, -2, v192
    buffer_store_dwordx4 v[192:195], v31, s[80:83], s20 offen offset:0 sc1
    v_accvgpr_read_b32 v112, a16
    s_waitcnt lgkmcnt(6)
    v_mfma_f32_32x32x16_bf16 a[32:47], a[128:131], v[240:243], a[32:47]
    ds_read_b64_tr_b16 a[124:125], v25 offset:20064
    ds_read_b64_tr_b16 a[126:127], v25 offset:20960
    buffer_load_dwordx4 v10, s[72:75], s98 offen offset:2048 lds
    v_accvgpr_read_b32 v113, a17
    v_accvgpr_read_b32 v114, a18
    v_mfma_f32_32x32x16_bf16 a[32:47], a[132:135], v[244:247], a[32:47]
    ds_read_b64_tr_b16 a[128:129], v25 offset:32864
    ds_read_b64_tr_b16 a[130:131], v25 offset:33760
    v_accvgpr_read_b32 v115, a19
    v_accvgpr_read_b32 v116, a20
    v_accvgpr_read_b32 v117, a21
    v_accvgpr_read_b32 v118, a22
    v_mfma_f32_32x32x16_bf16 a[32:47], a[136:139], v[248:251], a[32:47]
    ds_read_b64_tr_b16 a[132:133], v25 offset:36448
    ds_read_b64_tr_b16 a[134:135], v25 offset:37344
    buffer_load_dwordx4 v11, s[72:75], s98 offen offset:3072 lds
    v_accvgpr_read_b32 v119, a23
    v_accvgpr_read_b32 v120, a24
    v_accvgpr_read_b32 v121, a25
    v_mfma_f32_32x32x16_bf16 a[32:47], a[140:143], v[252:255], a[32:47]
    ds_read_b64_tr_b16 a[136:137], v25 offset:49248
    ds_read_b64_tr_b16 a[138:139], v25 offset:50144
    v_accvgpr_read_b32 v122, a26
    v_accvgpr_read_b32 v123, a27
    v_accvgpr_read_b32 v124, a28
    v_accvgpr_read_b32 v125, a29
    s_waitcnt lgkmcnt(6)
    v_mfma_f32_32x32x16_bf16 a[48:63], a[112:115], v[224:227], a[48:63]
    ds_read_b64_tr_b16 a[140:141], v25 offset:52832
    ds_read_b64_tr_b16 a[142:143], v25 offset:53728
    s_add_u32 m0, s101, 0x9000
    s_add_u32 s98, s37, 32768
    buffer_load_dwordx4 v8, s[72:75], s98 offen offset:0 lds
    v_mfma_f32_32x32x16_bf16 a[48:63], a[116:119], v[228:231], a[48:63]
    ds_read_b64_tr_b16 a[112:113], v25 offset:128
    ds_read_b64_tr_b16 a[114:115], v25 offset:1024
    v_accvgpr_read_b32 v126, a30
    v_accvgpr_read_b32 v127, a31
    v_mul_f32 v112, v112, v120
    v_mul_f32 v113, v113, v121
    v_mfma_f32_32x32x16_bf16 a[48:63], a[120:123], v[232:235], a[48:63]
    ds_read_b64_tr_b16 a[116:117], v25 offset:3712
    ds_read_b64_tr_b16 a[118:119], v25 offset:4608
    buffer_load_dwordx4 v9, s[72:75], s98 offen offset:1024 lds
    v_mul_f32 v114, v114, v122
    v_mul_f32 v115, v115, v123
    v_mul_f32 v116, v116, v124
    v_mfma_f32_32x32x16_bf16 a[48:63], a[124:127], v[236:239], a[48:63]
    ds_read_b64_tr_b16 a[120:121], v25 offset:16512
    ds_read_b64_tr_b16 a[122:123], v25 offset:17408
    v_mul_f32 v117, v117, v125
    v_mul_f32 v118, v118, v126
    v_mul_f32 v119, v119, v127
    v_cvt_pk_bf16_f32 v196, v112, v113
    s_waitcnt lgkmcnt(6)
    v_mfma_f32_32x32x16_bf16 a[48:63], a[128:131], v[240:243], a[48:63]
    ds_read_b64_tr_b16 a[124:125], v25 offset:20096
    ds_read_b64_tr_b16 a[126:127], v25 offset:20992
    buffer_load_dwordx4 v10, s[72:75], s98 offen offset:2048 lds
    v_cvt_pk_bf16_f32 v197, v114, v115
    v_cvt_pk_bf16_f32 v198, v116, v117
    v_mfma_f32_32x32x16_bf16 a[48:63], a[132:135], v[244:247], a[48:63]
    ds_read_b64_tr_b16 a[128:129], v25 offset:32896
    ds_read_b64_tr_b16 a[130:131], v25 offset:33792
    v_cvt_pk_bf16_f32 v199, v118, v119
    v_min_u32 v196, -2, v196
    buffer_store_dwordx4 v[196:199], v31, s[80:83], s20 offen offset:1024 sc1
    v_accvgpr_read_b32 v96, a32
    v_mfma_f32_32x32x16_bf16 a[48:63], a[136:139], v[248:251], a[48:63]
    ds_read_b64_tr_b16 a[132:133], v25 offset:36480
    ds_read_b64_tr_b16 a[134:135], v25 offset:37376
    v_accvgpr_read_b32 v97, a33
    v_accvgpr_read_b32 v98, a34
    v_accvgpr_read_b32 v99, a35
    v_accvgpr_read_b32 v100, a36
    v_mfma_f32_32x32x16_bf16 a[48:63], a[140:143], v[252:255], a[48:63]
    ds_read_b64_tr_b16 a[136:137], v25 offset:49280
    ds_read_b64_tr_b16 a[138:139], v25 offset:50176
    v_accvgpr_read_b32 v101, a37
    v_accvgpr_read_b32 v102, a38
    v_accvgpr_read_b32 v103, a39
    v_accvgpr_read_b32 v104, a40
    s_waitcnt lgkmcnt(6)
    v_mfma_f32_32x32x16_bf16 a[64:79], a[112:115], v[224:227], a[64:79]
    ds_read_b64_tr_b16 a[140:141], v25 offset:52864
    ds_read_b64_tr_b16 a[142:143], v25 offset:53760
    v_add_u32 v88, 4096, v31
    v_add_u32 v89, 8192, v31
    v_accvgpr_read_b32 v105, a41
    v_mfma_f32_32x32x16_bf16 a[64:79], a[116:119], v[228:231], a[64:79]
    ds_read_b64_tr_b16 a[112:113], v25 offset:160
    ds_read_b64_tr_b16 a[114:115], v25 offset:1056
    v_accvgpr_read_b32 v106, a42
    v_accvgpr_read_b32 v107, a43
    v_accvgpr_read_b32 v108, a44
    v_accvgpr_read_b32 v109, a45
    v_mfma_f32_32x32x16_bf16 a[64:79], a[120:123], v[232:235], a[64:79]
    ds_read_b64_tr_b16 a[116:117], v25 offset:3744
    ds_read_b64_tr_b16 a[118:119], v25 offset:4640
    v_accvgpr_read_b32 v110, a46
    v_accvgpr_read_b32 v111, a47
    v_mul_f32 v96, v96, v104
    v_mul_f32 v97, v97, v105
    v_mfma_f32_32x32x16_bf16 a[64:79], a[124:127], v[236:239], a[64:79]
    ds_read_b64_tr_b16 a[120:121], v25 offset:16544
    ds_read_b64_tr_b16 a[122:123], v25 offset:17440
    v_mul_f32 v98, v98, v106
    v_mul_f32 v99, v99, v107
    v_mul_f32 v100, v100, v108
    v_mul_f32 v101, v101, v109
    s_waitcnt lgkmcnt(6)
    v_mfma_f32_32x32x16_bf16 a[64:79], a[128:131], v[240:243], a[64:79]
    ds_read_b64_tr_b16 a[124:125], v25 offset:20128
    ds_read_b64_tr_b16 a[126:127], v25 offset:21024
    v_mul_f32 v102, v102, v110
    v_mul_f32 v103, v103, v111
    v_cvt_pk_bf16_f32 v200, v96, v97
    v_mfma_f32_32x32x16_bf16 a[64:79], a[132:135], v[244:247], a[64:79]
    ds_read_b64_tr_b16 a[128:129], v25 offset:32928
    ds_read_b64_tr_b16 a[130:131], v25 offset:33824
    v_cvt_pk_bf16_f32 v201, v98, v99
    v_cvt_pk_bf16_f32 v202, v100, v101
    v_cvt_pk_bf16_f32 v203, v102, v103
    v_min_u32 v200, -2, v200
    v_mfma_f32_32x32x16_bf16 a[64:79], a[136:139], v[248:251], a[64:79]
    ds_read_b64_tr_b16 a[132:133], v25 offset:36512
    ds_read_b64_tr_b16 a[134:135], v25 offset:37408
    buffer_store_dwordx4 v[200:203], v31, s[80:83], s20 offen offset:2048 sc1
    v_accvgpr_read_b32 v112, a48
    v_accvgpr_read_b32 v113, a49
    v_accvgpr_read_b32 v114, a50
    v_mfma_f32_32x32x16_bf16 a[64:79], a[140:143], v[252:255], a[64:79]
    ds_read_b64_tr_b16 a[136:137], v25 offset:49312
    ds_read_b64_tr_b16 a[138:139], v25 offset:50208
    v_accvgpr_read_b32 v115, a51
    v_accvgpr_read_b32 v116, a52
    v_accvgpr_read_b32 v117, a53
    v_accvgpr_read_b32 v118, a54
    s_waitcnt lgkmcnt(6)
    v_mfma_f32_32x32x16_bf16 a[80:95], a[112:115], v[224:227], a[80:95]
    ds_read_b64_tr_b16 a[140:141], v25 offset:52896
    ds_read_b64_tr_b16 a[142:143], v25 offset:53792
    v_accvgpr_read_b32 v119, a55
    v_accvgpr_read_b32 v120, a56
    v_accvgpr_read_b32 v121, a57
    v_mfma_f32_32x32x16_bf16 a[80:95], a[116:119], v[228:231], a[80:95]
    ds_read_b64_tr_b16 a[112:113], v25 offset:192
    ds_read_b64_tr_b16 a[114:115], v25 offset:1088
    v_accvgpr_read_b32 v122, a58
    v_accvgpr_read_b32 v123, a59
    v_accvgpr_read_b32 v124, a60
    v_accvgpr_read_b32 v125, a61
    v_mfma_f32_32x32x16_bf16 a[80:95], a[120:123], v[232:235], a[80:95]
    ds_read_b64_tr_b16 a[116:117], v25 offset:3776
    ds_read_b64_tr_b16 a[118:119], v25 offset:4672
    v_accvgpr_read_b32 v126, a62
    v_accvgpr_read_b32 v127, a63
    v_mul_f32 v112, v112, v120
    v_mul_f32 v113, v113, v121
    v_mfma_f32_32x32x16_bf16 a[80:95], a[124:127], v[236:239], a[80:95]
    ds_read_b64_tr_b16 a[120:121], v25 offset:16576
    ds_read_b64_tr_b16 a[122:123], v25 offset:17472
    v_mul_f32 v114, v114, v122
    v_mul_f32 v115, v115, v123
    v_mul_f32 v116, v116, v124
    v_mul_f32 v117, v117, v125
    s_waitcnt lgkmcnt(6)
    v_mfma_f32_32x32x16_bf16 a[80:95], a[128:131], v[240:243], a[80:95]
    ds_read_b64_tr_b16 a[124:125], v25 offset:20160
    ds_read_b64_tr_b16 a[126:127], v25 offset:21056
    s_waitcnt vmcnt(16)
    v_cmp_ne_u32 vcc, s41, v94
    s_and_b32 s99, vcc_lo, 31
    s_cbranch_scc1 L_slow_ps
L_back_ps:
    buffer_load_dwordx4 a[160:163], v31, s[80:83], s22 offen offset:0 sc1
    v_mfma_f32_32x32x16_bf16 a[80:95], a[132:135], v[244:247], a[80:95]
    ds_read_b64_tr_b16 a[128:129], v25 offset:32960
    ds_read_b64_tr_b16 a[130:131], v25 offset:33856
    v_mul_f32 v118, v118, v126
    v_mul_f32 v119, v119, v127
    v_cvt_pk_bf16_f32 v204, v112, v113
    v_cvt_pk_bf16_f32 v205, v114, v115
    v_mfma_f32_32x32x16_bf16 a[80:95], a[136:139], v[248:251], a[80:95]
    ds_read_b64_tr_b16 a[132:133], v25 offset:36544
    ds_read_b64_tr_b16 a[134:135], v25 offset:37440
    buffer_load_dwordx4 a[164:167], v31, s[80:83], s22 offen offset:1024 sc1
    v_cvt_pk_bf16_f32 v206, v116, v117
    v_cvt_pk_bf16_f32 v207, v118, v119
    v_min_u32 v204, -2, v204
    v_mfma_f32_32x32x16_bf16 a[80:95], a[140:143], v[252:255], a[80:95]
    ds_read_b64_tr_b16 a[136:137], v25 offset:49344
    ds_read_b64_tr_b16 a[138:139], v25 offset:50240
    buffer_store_dwordx4 v[204:207], v31, s[80:83], s20 offen offset:3072 sc1
    v_accvgpr_read_b32 v96, a64
    v_accvgpr_read_b32 v97, a65
    v_accvgpr_read_b32 v98, a66
    s_waitcnt lgkmcnt(6)
    v_mfma_f32_32x32x16_bf16 a[96:111], a[112:115], v[224:227], a[96:111]
    ds_read_b64_tr_b16 a[140:141], v25 offset:52928
    ds_read_b64_tr_b16 a[142:143], v25 offset:53824
    buffer_load_dwordx4 a[168:171], v31, s[80:83], s22 offen offset:2048 sc1
    v_accvgpr_read_b32 v99, a67
    v_accvgpr_read_b32 v100, a68
    v_mfma_f32_32x32x16_bf16 a[96:111], a[116:119], v[228:231], a[96:111]
    s_waitcnt vmcnt(14)
    s_barrier
    ds_read_b128 a[112:115], v52 offset:0
    v_accvgpr_read_b32 v101, a69
    v_accvgpr_read_b32 v102, a70
    v_accvgpr_read_b32 v103, a71
    v_mfma_f32_32x32x16_bf16 a[96:111], a[120:123], v[232:235], a[96:111]
    ds_read_b128 a[116:119], v52 offset:8192
    buffer_load_dwordx4 a[172:175], v31, s[80:83], s22 offen offset:3072 sc1
    v_accvgpr_read_b32 v104, a72
    v_accvgpr_read_b32 v105, a73
    v_accvgpr_read_b32 v106, a74
    v_accvgpr_read_b32 v107, a75
    v_mfma_f32_32x32x16_bf16 a[96:111], a[124:127], v[236:239], a[96:111]
    ds_read_b128 a[120:123], v52 offset:16384
    v_accvgpr_read_b32 v108, a76
    v_accvgpr_read_b32 v109, a77
    v_accvgpr_read_b32 v110, a78
    v_accvgpr_read_b32 v111, a79
    v_mul_f32 v96, v96, v104
    s_waitcnt lgkmcnt(3)
    v_mfma_f32_32x32x16_bf16 a[96:111], a[128:131], v[240:243], a[96:111]
    ds_read_b128 a[124:127], v53 offset:0
    buffer_load_dwordx4 a[176:179], v31, s[80:83], s23 offen offset:0 sc1
    v_mul_f32 v97, v97, v105
    v_mul_f32 v98, v98, v106
    v_mul_f32 v99, v99, v107
    v_mfma_f32_32x32x16_bf16 a[96:111], a[132:135], v[244:247], a[96:111]
    ds_read_b128 a[128:131], v53 offset:8192
    v_mul_f32 v100, v100, v108
    v_mul_f32 v101, v101, v109
    v_mul_f32 v102, v102, v110
    v_mul_f32 v103, v103, v111
    v_cvt_pk_bf16_f32 v208, v96, v97
    v_mfma_f32_32x32x16_bf16 a[96:111], a[136:139], v[248:251], a[96:111]
    ds_read_b128 a[132:135], v53 offset:16384
    buffer_load_dwordx4 a[180:183], v31, s[80:83], s23 offen offset:1024 sc1
    v_cvt_pk_bf16_f32 v209, v98, v99
    v_cvt_pk_bf16_f32 v210, v100, v101
    v_cvt_pk_bf16_f32 v211, v102, v103
    v_min_u32 v208, -2, v208
    v_mfma_f32_32x32x16_bf16 a[96:111], a[140:143], v[252:255], a[96:111]
    ds_read_b128 a[136:139], v20 offset:0
    s_add_u32 s20, s20, 4096
    buffer_store_dwordx4 v[208:211], v31, s[80:83], s20 offen offset:0 sc1
    v_accvgpr_read_b32 v112, a80
    v_accvgpr_read_b32 v113, a81
    v_accvgpr_read_b32 v114, a82
    s_waitcnt lgkmcnt(3)
    v_mfma_f32_32x32x16_bf16 v[128:143], a[144:147], a[112:115], 0
    ds_read_b128 a[140:143], v20 offset:8192
    buffer_load_dwordx4 a[184:187], v31, s[80:83], s23 offen offset:2048 sc1
    v_accvgpr_read_b32 v115, a83
    v_accvgpr_read_b32 v116, a84
    v_accvgpr_read_b32 v117, a85
    v_mfma_f32_32x32x16_bf16 v[144:159], a[144:147], a[116:119], 0
    ds_read_b128 a[112:115], v20 offset:16384
    v_accvgpr_read_b32 v118, a86
    v_accvgpr_read_b32 v119, a87
    v_accvgpr_read_b32 v120, a88
    v_accvgpr_read_b32 v121, a89
    v_accvgpr_read_b32 v122, a90
    v_mfma_f32_32x32x16_bf16 v[160:175], a[144:147], a[120:123], 0
    ds_read_b128 a[116:119], v21 offset:0
    buffer_load_dwordx4 a[188:191], v31, s[80:83], s23 offen offset:3072 sc1
    v_accvgpr_read_b32 v123, a91
    v_accvgpr_read_b32 v124, a92
    v_accvgpr_read_b32 v125, a93
    v_accvgpr_read_b32 v126, a94
    v_mfma_f32_32x32x16_bf16 v[128:143], a[148:151], a[124:127], v[128:143]
    ds_read_b128 a[120:123], v21 offset:8192
    v_accvgpr_read_b32 v127, a95
    v_mul_f32 v112, v112, v120
    v_mul_f32 v113, v113, v121
    v_mul_f32 v114, v114, v122
    v_mul_f32 v115, v115, v123
    s_waitcnt lgkmcnt(3)
    v_mfma_f32_32x32x16_bf16 v[144:159], a[148:151], a[128:131], v[144:159]
    ds_read_b128 a[124:127], v21 offset:16384
    buffer_load_dwordx4 a[192:195], v31, s[80:83], s24 offen offset:0 sc1
    v_mul_f32 v116, v116, v124
    v_mul_f32 v117, v117, v125
    v_mul_f32 v118, v118, v126
    v_mfma_f32_32x32x16_bf16 v[160:175], a[148:151], a[132:135], v[160:175]
    s_waitcnt vmcnt(13)
    s_barrier
    ds_read_b64_tr_b16 a[128:129], v56 offset:32768
    ds_read_b64_tr_b16 a[130:131], v57 offset:32768
    v_mul_f32 v119, v119, v127
    v_cvt_pk_bf16_f32 v212, v112, v113
    v_mfma_f32_32x32x16_bf16 v[128:143], a[152:155], a[136:139], v[128:143]
    ds_read_b64_tr_b16 a[132:133], v58 offset:32768
    ds_read_b64_tr_b16 a[134:135], v59 offset:32768
    buffer_load_dwordx4 a[196:199], v31, s[80:83], s24 offen offset:1024 sc1
    v_cvt_pk_bf16_f32 v213, v114, v115
    v_cvt_pk_bf16_f32 v214, v116, v117
    v_cvt_pk_bf16_f32 v215, v118, v119
    v_mfma_f32_32x32x16_bf16 v[144:159], a[152:155], a[140:143], v[144:159]
    ds_read_b64_tr_b16 a[136:137], v56 offset:49152
    ds_read_b64_tr_b16 a[138:139], v57 offset:49152
    v_min_u32 v212, -2, v212
    buffer_store_dwordx4 v[212:215], v31, s[80:83], s20 offen offset:1024 sc1
    v_accvgpr_read_b32 v96, a96
    v_accvgpr_read_b32 v97, a97
    s_waitcnt lgkmcnt(6)
    v_mfma_f32_32x32x16_bf16 v[160:175], a[152:155], a[112:115], v[160:175]
    ds_read_b64_tr_b16 a[140:141], v58 offset:49152
    ds_read_b64_tr_b16 a[142:143], v59 offset:49152
    buffer_load_dwordx4 a[200:203], v31, s[80:83], s24 offen offset:2048 sc1
    v_accvgpr_read_b32 v98, a98
    v_accvgpr_read_b32 v99, a99
    v_mfma_f32_32x32x16_bf16 v[128:143], a[156:159], a[116:119], v[128:143]
    ds_read_b64_tr_b16 a[112:113], v56 offset:34816
    ds_read_b64_tr_b16 a[114:115], v57 offset:34816
    v_accvgpr_read_b32 v100, a100
    v_accvgpr_read_b32 v101, a101
    v_accvgpr_read_b32 v102, a102
    v_accvgpr_read_b32 v103, a103
    v_mfma_f32_32x32x16_bf16 v[144:159], a[156:159], a[120:123], v[144:159]
    ds_read_b64_tr_b16 a[116:117], v58 offset:34816
    ds_read_b64_tr_b16 a[118:119], v59 offset:34816
    buffer_load_dwordx4 a[204:207], v31, s[80:83], s24 offen offset:3072 sc1
    v_accvgpr_read_b32 v104, a104
    v_accvgpr_read_b32 v105, a105
    v_accvgpr_read_b32 v106, a106
    v_mfma_f32_32x32x16_bf16 v[160:175], a[156:159], a[124:127], v[160:175]
    ds_read_b64_tr_b16 a[120:121], v56 offset:51200
    ds_read_b64_tr_b16 a[122:123], v57 offset:51200
    v_accvgpr_read_b32 v107, a107
    v_accvgpr_read_b32 v108, a108
    v_accvgpr_read_b32 v109, a109
    v_accvgpr_read_b32 v110, a110
    s_waitcnt lgkmcnt(6)
    v_mfma_f32_32x32x16_bf16 v[128:143], v[192:195], a[128:131], v[128:143]
    ds_read_b64_tr_b16 a[124:125], v58 offset:51200
    ds_read_b64_tr_b16 a[126:127], v59 offset:51200
    s_add_u32 m0, s101, 0x10000
    s_add_u32 s98, s38, 0
    buffer_load_dwordx4 v8, s[72:75], s98 offen offset:0 lds
    v_mfma_f32_32x32x16_bf16 v[144:159], v[192:195], a[132:135], v[144:159]
    ds_read_b64_tr_b16 a[128:129], v56 offset:36864
    ds_read_b64_tr_b16 a[130:131], v57 offset:36864
    v_accvgpr_read_b32 v111, a111
    v_mul_f32 v96, v96, v104
    v_mul_f32 v97, v97, v105
    v_mul_f32 v98, v98, v106
    v_mfma_f32_32x32x16_bf16 v[160:175], v[192:195], a[136:139], v[160:175]
    ds_read_b64_tr_b16 a[132:133], v58 offset:36864
    ds_read_b64_tr_b16 a[134:135], v59 offset:36864
    buffer_load_dwordx4 v9, s[72:75], s98 offen offset:1024 lds
    v_mul_f32 v99, v99, v107
    v_mul_f32 v100, v100, v108
    v_mul_f32 v101, v101, v109
    v_mfma_f32_32x32x16_bf16 v[176:191], v[192:195], a[140:143], 0
    ds_read_b64_tr_b16 a[136:137], v56 offset:53248
    ds_read_b64_tr_b16 a[138:139], v57 offset:53248
    v_mul_f32 v102, v102, v110
    v_mul_f32 v103, v103, v111
    v_cvt_pk_bf16_f32 v216, v96, v97
    v_cvt_pk_bf16_f32 v217, v98, v99
    s_waitcnt lgkmcnt(6)
    v_mfma_f32_32x32x16_bf16 v[128:143], v[196:199], a[112:115], v[128:143]
    ds_read_b64_tr_b16 a[140:141], v58 offset:53248
    ds_read_b64_tr_b16 a[142:143], v59 offset:53248
    buffer_load_dwordx4 v10, s[72:75], s98 offen offset:2048 lds
    v_cvt_pk_bf16_f32 v218, v100, v101
    v_cvt_pk_bf16_f32 v219, v102, v103
    v_mfma_f32_32x32x16_bf16 v[144:159], v[196:199], a[116:119], v[144:159]
    ds_read_b64_tr_b16 a[112:113], v56 offset:38912
    ds_read_b64_tr_b16 a[114:115], v57 offset:38912
    v_min_u32 v216, -2, v216
    buffer_store_dwordx4 v[216:219], v31, s[80:83], s20 offen offset:2048 sc1
    s_lshl_b32 s99, s3, 8
    v_lshl_add_u32 v64, v27, 2, s99
    v_lshl_add_u32 v65, v2, 6, s99
    v_mfma_f32_32x32x16_bf16 v[160:175], v[196:199], a[120:123], v[160:175]
    ds_read_b64_tr_b16 a[116:117], v58 offset:38912
    ds_read_b64_tr_b16 a[118:119], v59 offset:38912
    buffer_load_dwordx4 v11, s[72:75], s98 offen offset:3072 lds
    ds_write_b32 v64, v28 offset:47104
    ds_write_b32 v64, v29 offset:47232
    ds_read_b128 v[96:99], v65 offset:47104
    v_mfma_f32_32x32x16_bf16 v[176:191], v[196:199], a[124:127], v[176:191]
    ds_read_b64_tr_b16 a[120:121], v56 offset:55296
    ds_read_b64_tr_b16 a[122:123], v57 offset:55296
    ds_read_b128 v[112:115], v65 offset:47232
    ds_read_b128 v[100:103], v65 offset:47120
    ds_read_b128 v[116:119], v65 offset:47248
    ds_read_b128 v[104:107], v65 offset:47136
    s_waitcnt lgkmcnt(13)
    v_mfma_f32_32x32x16_bf16 v[128:143], v[200:203], a[128:131], v[128:143]
    ds_read_b64_tr_b16 a[124:125], v58 offset:55296
    ds_read_b64_tr_b16 a[126:127], v59 offset:55296
    s_add_u32 m0, s101, 0x11000
    s_add_u32 s98, s38, 32768
    buffer_load_dwordx4 v8, s[72:75], s98 offen offset:0 lds
    v_mfma_f32_32x32x16_bf16 v[144:159], v[200:203], a[132:135], v[144:159]
    ds_read_b64_tr_b16 a[128:129], v56 offset:40960
    ds_read_b64_tr_b16 a[130:131], v57 offset:40960
    ds_read_b128 v[120:123], v65 offset:47264
    ds_read_b128 v[108:111], v65 offset:47152
    ds_read_b128 v[124:127], v65 offset:47280
    v_mfma_f32_32x32x16_bf16 v[160:175], v[200:203], a[136:139], v[160:175]
    ds_read_b64_tr_b16 a[132:133], v58 offset:40960
    ds_read_b64_tr_b16 a[134:135], v59 offset:40960
    buffer_load_dwordx4 v9, s[72:75], s98 offen offset:1024 lds
    v_mfma_f32_32x32x16_bf16 v[176:191], v[200:203], a[140:143], v[176:191]
    ds_read_b64_tr_b16 a[136:137], v56 offset:57344
    ds_read_b64_tr_b16 a[138:139], v57 offset:57344
    s_waitcnt lgkmcnt(9)
    v_mfma_f32_32x32x16_bf16 v[128:143], v[204:207], a[112:115], v[128:143]
    ds_read_b64_tr_b16 a[140:141], v58 offset:57344
    ds_read_b64_tr_b16 a[142:143], v59 offset:57344
    buffer_load_dwordx4 v10, s[72:75], s98 offen offset:2048 lds
    v_mfma_f32_32x32x16_bf16 v[144:159], v[204:207], a[116:119], v[144:159]
    ds_read_b64_tr_b16 a[112:113], v56 offset:43008
    ds_read_b64_tr_b16 a[114:115], v57 offset:43008
    v_mfma_f32_32x32x16_bf16 v[160:175], v[204:207], a[120:123], v[160:175]
    ds_read_b64_tr_b16 a[116:117], v58 offset:43008
    ds_read_b64_tr_b16 a[118:119], v59 offset:43008
    s_add_u32 m0, s101, 0x18000
    s_add_u32 s98, s39, 0
    buffer_load_dwordx4 v8, s[72:75], s98 offen offset:0 lds
    v_mfma_f32_32x32x16_bf16 v[176:191], v[204:207], a[124:127], v[176:191]
    ds_read_b64_tr_b16 a[120:121], v56 offset:59392
    ds_read_b64_tr_b16 a[122:123], v57 offset:59392
    s_waitcnt lgkmcnt(6)
    v_mfma_f32_32x32x16_bf16 v[128:143], v[208:211], a[128:131], v[128:143]
    ds_read_b64_tr_b16 a[124:125], v58 offset:59392
    ds_read_b64_tr_b16 a[126:127], v59 offset:59392
    buffer_load_dwordx4 v9, s[72:75], s98 offen offset:1024 lds
    v_mfma_f32_32x32x16_bf16 v[144:159], v[208:211], a[132:135], v[144:159]
    ds_read_b64_tr_b16 a[128:129], v56 offset:45056
    ds_read_b64_tr_b16 a[130:131], v57 offset:45056
    v_mfma_f32_32x32x16_bf16 v[160:175], v[208:211], a[136:139], v[160:175]
    ds_read_b64_tr_b16 a[132:133], v58 offset:45056
    ds_read_b64_tr_b16 a[134:135], v59 offset:45056
    buffer_load_dwordx4 v10, s[72:75], s98 offen offset:2048 lds
    v_mfma_f32_32x32x16_bf16 v[176:191], v[208:211], a[140:143], v[176:191]
    ds_read_b64_tr_b16 a[136:137], v56 offset:61440
    ds_read_b64_tr_b16 a[138:139], v57 offset:61440
    s_waitcnt lgkmcnt(6)
    v_mfma_f32_32x32x16_bf16 v[128:143], v[212:215], a[112:115], v[128:143]
    ds_read_b64_tr_b16 a[140:141], v58 offset:61440
    ds_read_b64_tr_b16 a[142:143], v59 offset:61440
    buffer_load_dwordx4 v11, s[72:75], s98 offen offset:3072 lds
    v_mfma_f32_32x32x16_bf16 v[144:159], v[212:215], a[116:119], v[144:159]
    ds_read_b128 a[112:115], v54 offset:0
    v_mfma_f32_32x32x16_bf16 v[160:175], v[212:215], a[120:123], v[160:175]
    ds_read_b128 a[116:119], v54 offset:8192
    s_add_u32 m0, s101, 0x19000
    s_add_u32 s98, s39, 32768
    buffer_load_dwordx4 v8, s[72:75], s98 offen offset:0 lds
    v_mfma_f32_32x32x16_bf16 v[176:191], v[212:215], a[124:127], v[176:191]
    ds_read_b128 a[120:123], v54 offset:16384
    s_waitcnt lgkmcnt(3)
    v_mfma_f32_32x32x16_bf16 v[128:143], v[216:219], a[128:131], v[128:143]
    ds_read_b128 a[124:127], v55 offset:0
    buffer_load_dwordx4 v9, s[72:75], s98 offen offset:1024 lds
    v_mfma_f32_32x32x16_bf16 v[144:159], v[216:219], a[132:135], v[144:159]
    ds_read_b128 a[128:131], v55 offset:8192
    v_mfma_f32_32x32x16_bf16 v[160:175], v[216:219], a[136:139], v[160:175]
    ds_read_b128 a[132:135], v55 offset:16384
    buffer_load_dwordx4 v10, s[72:75], s98 offen offset:2048 lds
    v_mfma_f32_32x32x16_bf16 v[176:191], v[216:219], a[140:143], v[176:191]
    ds_read_b128 a[136:139], v22 offset:0
    s_lshl_b32 s98, s3, 14
    s_add_u32 m0, s98, 0x13800
    s_add_u32 s98, s29, 15360
    buffer_load_dwordx4 v91, s[48:51], s29 offen offset:0 lds
    buffer_load_dwordx4 v91, s[48:51], s98 offen offset:1024 lds
    s_waitcnt vmcnt(27)
    s_waitcnt lgkmcnt(3)
    v_mfma_f32_32x32x16_bf16 v[128:143], a[160:163], a[112:115], v[128:143]
    ds_read_b128 a[140:143], v22 offset:8192
    v_mfma_f32_32x32x16_bf16 v[144:159], a[160:163], a[116:119], v[144:159]
    ds_read_b128 a[112:115], v22 offset:16384
    buffer_load_dwordx4 a[0:3], v88, s[80:83], s22 offen offset:0 sc1
    v_mfma_f32_32x32x16_bf16 v[160:175], a[160:163], a[120:123], v[160:175]
    ds_read_b128 a[116:119], v23 offset:0
    v_mfma_f32_32x32x16_bf16 v[128:143], a[164:167], a[124:127], v[128:143]
    ds_read_b128 a[120:123], v23 offset:8192
    buffer_load_dwordx4 a[28:31], v88, s[80:83], s23 offen offset:0 sc1
    s_waitcnt lgkmcnt(3)
    v_mfma_f32_32x32x16_bf16 v[144:159], a[164:167], a[128:131], v[144:159]
    ds_read_b128 a[124:127], v23 offset:16384
    v_mfma_f32_32x32x16_bf16 v[160:175], a[164:167], a[132:135], v[160:175]
    ds_read_b128 a[128:131], v52 offset:4096
    buffer_load_dwordx4 a[56:59], v88, s[80:83], s24 offen offset:0 sc1
    v_mfma_f32_32x32x16_bf16 v[128:143], a[168:171], a[136:139], v[128:143]
    ds_read_b128 a[132:135], v52 offset:12288
    v_mfma_f32_32x32x16_bf16 v[144:159], a[168:171], a[140:143], v[144:159]
    ds_read_b128 a[136:139], v52 offset:20480
    buffer_load_dwordx4 a[4:7], v88, s[80:83], s22 offen offset:1024 sc1
    s_waitcnt lgkmcnt(3)
    v_mfma_f32_32x32x16_bf16 v[160:175], a[168:171], a[112:115], v[160:175]
    ds_read_b128 a[140:143], v53 offset:4096
    v_mfma_f32_32x32x16_bf16 v[128:143], a[172:175], a[116:119], v[128:143]
    ds_read_b128 a[112:115], v53 offset:12288
    buffer_load_dwordx4 a[32:35], v88, s[80:83], s23 offen offset:1024 sc1
    v_mfma_f32_32x32x16_bf16 v[144:159], a[172:175], a[120:123], v[144:159]
    ds_read_b128 a[116:119], v53 offset:20480
    v_mfma_f32_32x32x16_bf16 v[160:175], a[172:175], a[124:127], v[160:175]
    ds_read_b128 a[120:123], v20 offset:4096
    buffer_load_dwordx4 a[60:63], v88, s[80:83], s24 offen offset:1024 sc1
    s_waitcnt vmcnt(28)
    s_waitcnt lgkmcnt(3)
    v_mfma_f32_32x32x16_bf16 v[128:143], a[176:179], a[128:131], v[128:143]
    ds_read_b128 a[124:127], v20 offset:12288
    v_mfma_f32_32x32x16_bf16 v[144:159], a[176:179], a[132:135], v[144:159]
    ds_read_b128 a[128:131], v20 offset:20480
    buffer_load_dwordx4 a[8:11], v88, s[80:83], s22 offen offset:2048 sc1
    v_mfma_f32_32x32x16_bf16 v[160:175], a[176:179], a[136:139], v[160:175]
    ds_read_b128 a[132:135], v21 offset:4096
    v_mfma_f32_32x32x16_bf16 v[128:143], a[180:183], a[140:143], v[128:143]
    ds_read_b128 a[136:139], v21 offset:12288
    buffer_load_dwordx4 a[36:39], v88, s[80:83], s23 offen offset:2048 sc1
    s_waitcnt lgkmcnt(3)
    v_mfma_f32_32x32x16_bf16 v[144:159], a[180:183], a[112:115], v[144:159]
    ds_read_b128 a[140:143], v21 offset:20480
    v_mfma_f32_32x32x16_bf16 v[160:175], a[180:183], a[116:119], v[160:175]
    ds_read_b128 a[112:115], v54 offset:4096
    buffer_load_dwordx4 a[64:67], v88, s[80:83], s24 offen offset:2048 sc1
    v_mfma_f32_32x32x16_bf16 v[128:143], a[184:187], a[120:123], v[128:143]
    ds_read_b128 a[116:119], v54 offset:12288
    v_mfma_f32_32x32x16_bf16 v[144:159], a[184:187], a[124:127], v[144:159]
    ds_read_b128 a[120:123], v54 offset:20480
    buffer_load_dwordx4 a[12:15], v88, s[80:83], s22 offen offset:3072 sc1
    s_waitcnt lgkmcnt(3)
    v_mfma_f32_32x32x16_bf16 v[160:175], a[184:187], a[128:131], v[160:175]
    ds_read_b128 a[124:127], v55 offset:4096
    v_mfma_f32_32x32x16_bf16 v[128:143], a[188:191], a[132:135], v[128:143]
    ds_read_b128 a[128:131], v55 offset:12288
    buffer_load_dwordx4 a[40:43], v88, s[80:83], s23 offen offset:3072 sc1
    v_mfma_f32_32x32x16_bf16 v[144:159], a[188:191], a[136:139], v[144:159]
    ds_read_b128 a[132:135], v55 offset:20480
    v_mfma_f32_32x32x16_bf16 v[160:175], a[188:191], a[140:143], v[160:175]
    ds_read_b128 a[136:139], v22 offset:4096
    buffer_load_dwordx4 a[68:71], v88, s[80:83], s24 offen offset:3072 sc1
    s_waitcnt vmcnt(29)
    s_waitcnt lgkmcnt(3)
    v_mfma_f32_32x32x16_bf16 v[128:143], a[192:195], a[112:115], v[128:143]
    ds_read_b128 a[140:143], v22 offset:12288
    buffer_load_dwordx4 a[16:19], v89, s[80:83], s22 offen offset:0 sc1
    v_mfma_f32_32x32x16_bf16 v[144:159], a[192:195], a[116:119], v[144:159]
    ds_read_b128 a[112:115], v22 offset:20480
    buffer_load_dwordx4 a[20:23], v89, s[80:83], s22 offen offset:1024 sc1
    v_mfma_f32_32x32x16_bf16 v[160:175], a[192:195], a[120:123], v[160:175]
    ds_read_b128 a[116:119], v23 offset:4096
    buffer_load_dwordx4 a[24:27], v89, s[80:83], s22 offen offset:2048 sc1
    v_mfma_f32_32x32x16_bf16 v[128:143], a[196:199], a[124:127], v[128:143]
    ds_read_b128 a[120:123], v23 offset:12288
    buffer_load_dwordx4 a[44:47], v89, s[80:83], s23 offen offset:0 sc1
    s_waitcnt lgkmcnt(3)
    v_mfma_f32_32x32x16_bf16 v[144:159], a[196:199], a[128:131], v[144:159]
    ds_read_b128 a[124:127], v23 offset:20480
    buffer_load_dwordx4 a[48:51], v89, s[80:83], s23 offen offset:1024 sc1
    v_mfma_f32_32x32x16_bf16 v[160:175], a[196:199], a[132:135], v[160:175]
    s_waitcnt vmcnt(19)
    s_barrier
    ds_read_b64_tr_b16 a[128:129], v60 offset:0
    ds_read_b64_tr_b16 a[130:131], v61 offset:0
    buffer_load_dwordx4 a[52:55], v89, s[80:83], s23 offen offset:2048 sc1
    v_mfma_f32_32x32x16_bf16 v[128:143], a[200:203], a[136:139], v[128:143]
    ds_read_b64_tr_b16 a[132:133], v60 offset:2048
    ds_read_b64_tr_b16 a[134:135], v61 offset:2048
    buffer_load_dwordx4 a[72:75], v89, s[80:83], s24 offen offset:0 sc1
    s_waitcnt vmcnt(19)
    ds_read_b64_tr_b16 v[224:225], v87 offset:0
    v_mfma_f32_32x32x16_bf16 v[144:159], a[200:203], a[140:143], v[144:159]
    ds_read_b64_tr_b16 a[136:137], v60 offset:4096
    ds_read_b64_tr_b16 a[138:139], v61 offset:4096
    buffer_load_dwordx4 a[76:79], v89, s[80:83], s24 offen offset:1024 sc1
    ds_read_b64_tr_b16 v[226:227], v87 offset:256
    ds_read_b64_tr_b16 v[228:229], v87 offset:512
    s_waitcnt lgkmcnt(9)
    v_mfma_f32_32x32x16_bf16 v[160:175], a[200:203], a[112:115], v[160:175]
    ds_read_b64_tr_b16 a[140:141], v60 offset:6144
    ds_read_b64_tr_b16 a[142:143], v61 offset:6144
    buffer_load_dwordx4 a[80:83], v89, s[80:83], s24 offen offset:2048 sc1
    ds_read_b64_tr_b16 v[230:231], v87 offset:768
    v_mfma_f32_32x32x16_bf16 v[128:143], a[204:207], a[116:119], v[128:143]
    ds_read_b64_tr_b16 a[112:113], v60 offset:8192
    ds_read_b64_tr_b16 a[114:115], v61 offset:8192
    v_lshlrev_b32 v93, 16, v93
    v_mfma_f32_32x32x16_bf16 v[144:159], a[204:207], a[120:123], v[144:159]
    ds_read_b64_tr_b16 a[116:117], v60 offset:10240
    ds_read_b64_tr_b16 a[118:119], v61 offset:10240
    s_add_u32 m0, s101, 0x8000
    s_add_u32 s98, s40, 0
    buffer_load_dwordx4 v8, s[72:75], s98 offen offset:0 lds
    v_mfma_f32_32x32x16_bf16 v[160:175], a[204:207], a[124:127], v[160:175]
    ds_read_b64_tr_b16 a[120:121], v60 offset:12288
    ds_read_b64_tr_b16 a[122:123], v61 offset:12288
    s_waitcnt vmcnt(7)
    v_accvgpr_read_b32 v72, a0
    v_accvgpr_read_b32 v73, a4
    v_accvgpr_read_b32 v74, a8
    v_accvgpr_read_b32 v75, a12
    v_accvgpr_read_b32 v76, a16
    v_accvgpr_read_b32 v77, a20
    v_accvgpr_read_b32 v78, a24
    v_max3_u32 v72, v72, v73, v74
    v_max3_u32 v75, v75, v76, v77
    v_max3_u32 v72, v72, v75, v78
    v_cmp_eq_u32 vcc, -1, v72
    s_nop 0
    s_cbranch_vccnz L_slow_hf1
L_back_hf1:
    s_waitcnt lgkmcnt(7)
    v_mfma_f32_32x32x16_bf16 v[128:143], a[0:3], a[128:131], v[128:143]
    ds_read_b64_tr_b16 a[124:125], v60 offset:16384
    ds_read_b64_tr_b16 a[126:127], v61 offset:16384
    buffer_load_dwordx4 v9, s[72:75], s98 offen offset:1024 lds
    s_waitcnt lgkmcnt(8)
    v_mfma_f32_32x32x16_bf16 v[128:143], a[4:7], a[132:135], v[128:143]
    ds_read_b64_tr_b16 a[128:129], v60 offset:18432
    ds_read_b64_tr_b16 a[130:131], v61 offset:18432
    v_lshlrev_b32 v240, 16, v224
    v_and_b32 v241, s14, v224
    v_sub_f32 v64, v240, v96
    v_mfma_f32_32x32x16_bf16 v[128:143], a[8:11], a[136:139], v[128:143]
    ds_read_b64_tr_b16 a[132:133], v60 offset:20480
    ds_read_b64_tr_b16 a[134:135], v61 offset:20480
    buffer_load_dwordx4 v10, s[72:75], s98 offen offset:2048 lds
    v_sub_f32 v65, v241, v97
    v_cvt_pk_bf16_f32 v65, v64, v65
    v_mfma_f32_32x32x16_bf16 v[128:143], a[12:15], a[140:143], v[128:143]
    ds_read_b64_tr_b16 a[136:137], v60 offset:22528
    ds_read_b64_tr_b16 a[138:139], v61 offset:22528
    v_lshlrev_b32 v64, 16, v65
    v_and_b32 v65, s14, v65
    v_mul_f32 v64, v64, v112
    s_waitcnt lgkmcnt(6)
    v_mfma_f32_32x32x16_bf16 v[128:143], a[16:19], a[112:115], v[128:143]
    ds_read_b64_tr_b16 a[140:141], v60 offset:24576
    ds_read_b64_tr_b16 a[142:143], v61 offset:24576
    buffer_load_dwordx4 v11, s[72:75], s98 offen offset:3072 lds
    v_mul_f32 v65, v65, v113
    v_mfma_f32_32x32x16_bf16 v[128:143], a[20:23], a[116:119], v[128:143]
    ds_read_b64_tr_b16 a[112:113], v60 offset:26624
    ds_read_b64_tr_b16 a[114:115], v61 offset:26624
    v_cvt_pk_bf16_f32 v65, v64, v65
    v_lshlrev_b32 v64, 16, v65
    v_and_b32 v65, s14, v65
    v_mfma_f32_32x32x16_bf16 v[128:143], a[24:27], a[120:123], v[128:143]
    ds_read_b64_tr_b16 a[116:117], v60 offset:28672
    ds_read_b64_tr_b16 a[118:119], v61 offset:28672
    s_waitcnt vmcnt(7)
    v_accvgpr_read_b32 v72, a28
    v_accvgpr_read_b32 v73, a32
    v_accvgpr_read_b32 v74, a36
    v_accvgpr_read_b32 v75, a40
    v_accvgpr_read_b32 v76, a44
    v_accvgpr_read_b32 v77, a48
    v_accvgpr_read_b32 v78, a52
    v_max3_u32 v72, v72, v73, v74
    v_max3_u32 v75, v75, v76, v77
    v_max3_u32 v72, v72, v75, v78
    v_cmp_eq_u32 vcc, -1, v72
    s_nop 0
    s_cbranch_vccnz L_slow_hf2
L_back_hf2:
    s_add_u32 m0, s101, 0x9000
    s_add_u32 s98, s40, 32768
    buffer_load_dwordx4 v8, s[72:75], s98 offen offset:0 lds
    v_mfma_f32_32x32x16_bf16 v[128:143], a[28:31], a[124:127], v[128:143]
    ds_read_b64_tr_b16 a[120:121], v60 offset:32768
    ds_read_b64_tr_b16 a[122:123], v61 offset:32768
    v_mul_f32 v64, v64, v93
    v_mul_f32 v65, v65, v93
    v_cvt_pk_bf16_f32 v65, v64, v65
    s_waitcnt lgkmcnt(6)
    v_mfma_f32_32x32x16_bf16 v[128:143], a[32:35], a[128:131], v[128:143]
    ds_read_b64_tr_b16 a[124:125], v60 offset:34816
    ds_read_b64_tr_b16 a[126:127], v61 offset:34816
    buffer_load_dwordx4 v9, s[72:75], s98 offen offset:1024 lds
    v_lshlrev_b32 v64, 16, v65
    v_mfma_f32_32x32x16_bf16 v[128:143], a[36:39], a[132:135], v[128:143]
    ds_read_b64_tr_b16 a[128:129], v60 offset:36864
    ds_read_b64_tr_b16 a[130:131], v61 offset:36864
    v_and_b32 v65, s14, v65
    v_add_f32 v240, v240, v64
    v_add_f32 v241, v241, v65
    v_mfma_f32_32x32x16_bf16 v[128:143], a[40:43], a[136:139], v[128:143]
    ds_read_b64_tr_b16 a[132:133], v60 offset:38912
    ds_read_b64_tr_b16 a[134:135], v61 offset:38912
    buffer_load_dwordx4 v10, s[72:75], s98 offen offset:2048 lds
    v_mul_f32 v112, v112, v112
    v_mul_f32 v113, v113, v113
    v_mfma_f32_32x32x16_bf16 v[128:143], a[44:47], a[140:143], v[128:143]
    ds_read_b64_tr_b16 a[136:137], v60 offset:40960
    ds_read_b64_tr_b16 a[138:139], v61 offset:40960
    v_lshlrev_b32 v242, 16, v225
    v_and_b32 v243, s14, v225
    v_sub_f32 v66, v242, v98
    s_waitcnt lgkmcnt(6)
    v_mfma_f32_32x32x16_bf16 v[128:143], a[48:51], a[112:115], v[128:143]
    ds_read_b64_tr_b16 a[140:141], v60 offset:43008
    ds_read_b64_tr_b16 a[142:143], v61 offset:43008
    v_sub_f32 v67, v243, v99
    v_cvt_pk_bf16_f32 v67, v66, v67
    v_mfma_f32_32x32x16_bf16 v[128:143], a[52:55], a[116:119], v[128:143]
    ds_read_b64_tr_b16 a[112:113], v60 offset:45056
    ds_read_b64_tr_b16 a[114:115], v61 offset:45056
    s_waitcnt vmcnt(7)
    v_accvgpr_read_b32 v72, a56
    v_accvgpr_read_b32 v73, a60
    v_accvgpr_read_b32 v74, a64
    v_accvgpr_read_b32 v75, a68
    v_accvgpr_read_b32 v76, a72
    v_accvgpr_read_b32 v77, a76
    v_accvgpr_read_b32 v78, a80
    v_max3_u32 v72, v72, v73, v74
    v_max3_u32 v75, v75, v76, v77
    v_max3_u32 v72, v72, v75, v78
    v_cmp_eq_u32 vcc, -1, v72
    s_nop 0
    s_cbranch_vccnz L_slow_hf3
L_back_hf3:
    v_mfma_f32_32x32x16_bf16 v[128:143], a[56:59], a[120:123], v[128:143]
    ds_read_b64_tr_b16 a[116:117], v62 offset:0
    ds_read_b64_tr_b16 a[118:119], v63 offset:0
    v_lshlrev_b32 v66, 16, v67
    v_and_b32 v67, s14, v67
    v_mul_f32 v66, v66, v114
    v_mfma_f32_32x32x16_bf16 v[128:143], a[60:63], a[124:127], v[128:143]
    ds_read_b64_tr_b16 a[120:121], v62 offset:2048
    ds_read_b64_tr_b16 a[122:123], v63 offset:2048
    v_mul_f32 v67, v67, v115
    v_cvt_pk_bf16_f32 v67, v66, v67
    v_lshlrev_b32 v66, 16, v67
    s_waitcnt lgkmcnt(6)
    v_mfma_f32_32x32x16_bf16 v[128:143], a[64:67], a[128:131], v[128:143]
    ds_read_b64_tr_b16 a[124:125], v62 offset:4096
    ds_read_b64_tr_b16 a[126:127], v63 offset:4096
    v_and_b32 v67, s14, v67
    v_mul_f32 v66, v66, v93
    v_mfma_f32_32x32x16_bf16 v[128:143], a[68:71], a[132:135], v[128:143]
    ds_read_b64_tr_b16 a[128:129], v62 offset:6144
    ds_read_b64_tr_b16 a[130:131], v63 offset:6144
    v_mul_f32 v67, v67, v93
    v_cvt_pk_bf16_f32 v67, v66, v67
    v_lshlrev_b32 v66, 16, v67
    v_mfma_f32_32x32x16_bf16 v[128:143], a[72:75], a[136:139], v[128:143]
    ds_read_b64_tr_b16 a[132:133], v62 offset:8192
    ds_read_b64_tr_b16 a[134:135], v63 offset:8192
    v_and_b32 v67, s14, v67
    v_add_f32 v242, v242, v66
    v_add_f32 v243, v243, v67
    v_mfma_f32_32x32x16_bf16 v[128:143], a[76:79], a[140:143], v[128:143]
    ds_read_b64_tr_b16 a[136:137], v62 offset:10240
    ds_read_b64_tr_b16 a[138:139], v63 offset:10240
    v_mul_f32 v114, v114, v114
    v_mul_f32 v115, v115, v115
    v_lshlrev_b32 v244, 16, v226
    s_waitcnt lgkmcnt(6)
    v_mfma_f32_32x32x16_bf16 v[128:143], a[80:83], a[112:115], v[128:143]
    ds_read_b64_tr_b16 a[140:141], v62 offset:12288
    ds_read_b64_tr_b16 a[142:143], v63 offset:12288
    v_and_b32 v245, s14, v226
    v_sub_f32 v64, v244, v100
    v_mfma_f32_32x32x16_bf16 v[144:159], a[0:3], a[116:119], v[144:159]
    ds_read_b64_tr_b16 a[112:113], v62 offset:16384
    ds_read_b64_tr_b16 a[114:115], v63 offset:16384
    v_sub_f32 v65, v245, v101
    v_cvt_pk_bf16_f32 v65, v64, v65
    v_lshlrev_b32 v64, 16, v65
    v_mfma_f32_32x32x16_bf16 v[144:159], a[4:7], a[120:123], v[144:159]
    ds_read_b64_tr_b16 a[116:117], v62 offset:18432
    ds_read_b64_tr_b16 a[118:119], v63 offset:18432
    v_and_b32 v65, s14, v65
    v_mul_f32 v64, v64, v116
    v_mul_f32 v65, v65, v117
    v_mfma_f32_32x32x16_bf16 v[144:159], a[8:11], a[124:127], v[144:159]
    ds_read_b64_tr_b16 a[120:121], v62 offset:20480
    ds_read_b64_tr_b16 a[122:123], v63 offset:20480
    v_cvt_pk_bf16_f32 v72, v128, v129
    v_cvt_pk_bf16_f32 v73, v130, v131
    v_cvt_pk_bf16_f32 v74, v132, v133
    s_waitcnt lgkmcnt(6)
    v_mfma_f32_32x32x16_bf16 v[144:159], a[12:15], a[128:131], v[144:159]
    ds_read_b64_tr_b16 a[124:125], v62 offset:22528
    ds_read_b64_tr_b16 a[126:127], v63 offset:22528
    v_mov_b32 v75, s41
    v_cvt_pk_bf16_f32 v76, v134, v135
    v_mfma_f32_32x32x16_bf16 v[144:159], a[16:19], a[132:135], v[144:159]
    ds_read_b64_tr_b16 a[128:129], v62 offset:24576
    ds_read_b64_tr_b16 a[130:131], v63 offset:24576
    v_cvt_pk_bf16_f32 v77, v136, v137
    v_cvt_pk_bf16_f32 v78, v138, v139
    v_mov_b32 v79, s41
    v_mfma_f32_32x32x16_bf16 v[144:159], a[20:23], a[136:139], v[144:159]
    ds_read_b64_tr_b16 a[132:133], v62 offset:26624
    ds_read_b64_tr_b16 a[134:135], v63 offset:26624
    v_cvt_pk_bf16_f32 v80, v140, v141
    v_cvt_pk_bf16_f32 v81, v142, v143
    v_mov_b32 v83, s41
    v_mfma_f32_32x32x16_bf16 v[144:159], a[24:27], a[140:143], v[144:159]
    ds_read_b64_tr_b16 a[136:137], v62 offset:28672
    ds_read_b64_tr_b16 a[138:139], v63 offset:28672
    v_cvt_pk_bf16_f32 v65, v64, v65
    v_lshlrev_b32 v64, 16, v65
    v_and_b32 v65, s14, v65
    s_waitcnt lgkmcnt(6)
    v_mfma_f32_32x32x16_bf16 v[144:159], a[28:31], a[112:115], v[144:159]
    ds_read_b64_tr_b16 a[140:141], v62 offset:32768
    ds_read_b64_tr_b16 a[142:143], v63 offset:32768
    buffer_store_dwordx4 v[72:75], v31, s[80:83], s25 offen offset:0 sc1
    v_mul_f32 v64, v64, v93
    v_mfma_f32_32x32x16_bf16 v[144:159], a[32:35], a[116:119], v[144:159]
    ds_read_b64_tr_b16 a[112:113], v62 offset:34816
    ds_read_b64_tr_b16 a[114:115], v63 offset:34816
    v_mul_f32 v65, v65, v93
    v_cvt_pk_bf16_f32 v65, v64, v65
    v_lshlrev_b32 v64, 16, v65
    v_mfma_f32_32x32x16_bf16 v[144:159], a[36:39], a[120:123], v[144:159]
    ds_read_b64_tr_b16 a[116:117], v62 offset:36864
    ds_read_b64_tr_b16 a[118:119], v63 offset:36864
    buffer_store_dwordx4 v[76:79], v31, s[80:83], s25 offen offset:1024 sc1
    v_and_b32 v65, s14, v65
    v_add_f32 v244, v244, v64
    v_mfma_f32_32x32x16_bf16 v[144:159], a[40:43], a[124:127], v[144:159]
    ds_read_b64_tr_b16 a[120:121], v62 offset:38912
    ds_read_b64_tr_b16 a[122:123], v63 offset:38912
    v_add_f32 v245, v245, v65
    v_mul_f32 v116, v116, v116
    v_mul_f32 v117, v117, v117
    s_waitcnt lgkmcnt(6)
    v_mfma_f32_32x32x16_bf16 v[144:159], a[44:47], a[128:131], v[144:159]
    ds_read_b64_tr_b16 a[124:125], v62 offset:40960
    ds_read_b64_tr_b16 a[126:127], v63 offset:40960
    buffer_store_dwordx4 v[80:83], v31, s[80:83], s25 offen offset:2048 sc1
    v_lshlrev_b32 v246, 16, v227
    v_mfma_f32_32x32x16_bf16 v[144:159], a[48:51], a[132:135], v[144:159]
    ds_read_b64_tr_b16 a[128:129], v62 offset:43008
    ds_read_b64_tr_b16 a[130:131], v63 offset:43008
    v_and_b32 v247, s14, v227
    v_sub_f32 v66, v246, v102
    v_sub_f32 v67, v247, v103
    v_mfma_f32_32x32x16_bf16 v[144:159], a[52:55], a[136:139], v[144:159]
    ds_read_b64_tr_b16 a[132:133], v62 offset:45056
    ds_read_b64_tr_b16 a[134:135], v63 offset:45056
    v_cvt_pk_bf16_f32 v67, v66, v67
    v_lshlrev_b32 v66, 16, v67
    v_and_b32 v67, s14, v67
    v_mfma_f32_32x32x16_bf16 v[144:159], a[56:59], a[140:143], v[144:159]
    ds_read_b64_tr_b16 a[136:137], v60 offset:49152
    ds_read_b64_tr_b16 a[138:139], v61 offset:49152
    v_mul_f32 v66, v66, v118
    v_mul_f32 v67, v67, v119
    v_cvt_pk_bf16_f32 v67, v66, v67
    s_waitcnt lgkmcnt(6)
    v_mfma_f32_32x32x16_bf16 v[144:159], a[60:63], a[112:115], v[144:159]
    ds_read_b64_tr_b16 a[140:141], v60 offset:51200
    ds_read_b64_tr_b16 a[142:143], v61 offset:51200
    v_lshlrev_b32 v66, 16, v67
    v_and_b32 v67, s14, v67
    v_mfma_f32_32x32x16_bf16 v[144:159], a[64:67], a[116:119], v[144:159]
    ds_read_b64_tr_b16 a[112:113], v60 offset:53248
    ds_read_b64_tr_b16 a[114:115], v61 offset:53248
    v_mul_f32 v66, v66, v93
    v_mul_f32 v67, v67, v93
    v_cvt_pk_bf16_f32 v67, v66, v67
    v_mfma_f32_32x32x16_bf16 v[144:159], a[68:71], a[120:123], v[144:159]
    ds_read_b64_tr_b16 a[116:117], v60 offset:55296
    ds_read_b64_tr_b16 a[118:119], v61 offset:55296
    v_lshlrev_b32 v66, 16, v67
    v_and_b32 v67, s14, v67
    v_add_f32 v246, v246, v66
    v_mfma_f32_32x32x16_bf16 v[144:159], a[72:75], a[124:127], v[144:159]
    ds_read_b64_tr_b16 a[120:121], v60 offset:57344
    ds_read_b64_tr_b16 a[122:123], v61 offset:57344
    v_add_f32 v247, v247, v67
    v_mul_f32 v118, v118, v118
    v_mul_f32 v119, v119, v119
    s_waitcnt lgkmcnt(6)
    v_mfma_f32_32x32x16_bf16 v[144:159], a[76:79], a[128:131], v[144:159]
    ds_read_b64_tr_b16 a[124:125], v60 offset:59392
    ds_read_b64_tr_b16 a[126:127], v61 offset:59392
    v_lshlrev_b32 v248, 16, v228
    v_and_b32 v249, s14, v228
    v_mfma_f32_32x32x16_bf16 v[144:159], a[80:83], a[132:135], v[144:159]
    ds_read_b64_tr_b16 a[128:129], v60 offset:61440
    ds_read_b64_tr_b16 a[130:131], v61 offset:61440
    v_sub_f32 v64, v248, v104
    v_sub_f32 v65, v249, v105
    v_cvt_pk_bf16_f32 v65, v64, v65
    v_mfma_f32_32x32x16_bf16 v[160:175], a[0:3], a[136:139], v[160:175]
    s_waitcnt vmcnt(3)
    s_barrier
    ds_read_b64_tr_b16 a[132:133], v56 offset:32768
    ds_read_b64_tr_b16 a[134:135], v57 offset:32768
    v_lshlrev_b32 v64, 16, v65
    v_mfma_f32_32x32x16_bf16 v[160:175], a[4:7], a[140:143], v[160:175]
    ds_read_b64_tr_b16 a[136:137], v56 offset:34816
    ds_read_b64_tr_b16 a[138:139], v57 offset:34816
    v_and_b32 v65, s14, v65
    v_mul_f32 v64, v64, v120
    v_mul_f32 v65, v65, v121
    s_waitcnt lgkmcnt(6)
    v_mfma_f32_32x32x16_bf16 v[160:175], a[8:11], a[112:115], v[160:175]
    ds_read_b64_tr_b16 a[140:141], v56 offset:36864
    ds_read_b64_tr_b16 a[142:143], v57 offset:36864
    v_cvt_pk_bf16_f32 v192, v144, v145
    v_cvt_pk_bf16_f32 v193, v146, v147
    v_mfma_f32_32x32x16_bf16 v[160:175], a[12:15], a[116:119], v[160:175]
    ds_read_b64_tr_b16 a[112:113], v56 offset:38912
    ds_read_b64_tr_b16 a[114:115], v57 offset:38912
    v_cvt_pk_bf16_f32 v194, v148, v149
    v_cvt_pk_bf16_f32 v195, v150, v151
    v_min_u32 v192, -2, v192
    v_mfma_f32_32x32x16_bf16 v[160:175], a[16:19], a[120:123], v[160:175]
    ds_read_b64_tr_b16 a[116:117], v56 offset:40960
    ds_read_b64_tr_b16 a[118:119], v57 offset:40960
    v_cvt_pk_bf16_f32 v196, v152, v153
    v_cvt_pk_bf16_f32 v197, v154, v155
    v_cvt_pk_bf16_f32 v198, v156, v157
    v_mfma_f32_32x32x16_bf16 v[160:175], a[20:23], a[124:127], v[160:175]
    ds_read_b64_tr_b16 a[120:121], v56 offset:43008
    ds_read_b64_tr_b16 a[122:123], v57 offset:43008
    v_cvt_pk_bf16_f32 v199, v158, v159
    v_min_u32 v196, -2, v196
    v_cvt_pk_bf16_f32 v65, v64, v65
    s_waitcnt lgkmcnt(6)
    v_mfma_f32_32x32x16_bf16 v[160:175], a[24:27], a[128:131], v[160:175]
    ds_read_b64_tr_b16 a[124:125], v56 offset:45056
    ds_read_b64_tr_b16 a[126:127], v57 offset:45056
    buffer_store_dwordx4 v[192:195], v31, s[80:83], s26 offen offset:0 sc1
    v_lshlrev_b32 v64, 16, v65
    v_mfma_f32_32x32x16_bf16 v[160:175], a[28:31], a[132:135], v[160:175]
    ds_read_b64_tr_b16 a[128:129], v56 offset:49152
    ds_read_b64_tr_b16 a[130:131], v57 offset:49152
    v_and_b32 v65, s14, v65
    v_mul_f32 v64, v64, v93
    v_mul_f32 v65, v65, v93
    v_mfma_f32_32x32x16_bf16 v[160:175], a[32:35], a[136:139], v[160:175]
    ds_read_b64_tr_b16 a[132:133], v56 offset:51200
    ds_read_b64_tr_b16 a[134:135], v57 offset:51200
    buffer_store_dwordx4 v[196:199], v31, s[80:83], s26 offen offset:1024 sc1
    v_cvt_pk_bf16_f32 v65, v64, v65
    v_lshlrev_b32 v64, 16, v65
    v_mfma_f32_32x32x16_bf16 v[160:175], a[36:39], a[140:143], v[160:175]
    ds_read_b64_tr_b16 a[136:137], v56 offset:53248
    ds_read_b64_tr_b16 a[138:139], v57 offset:53248
    v_and_b32 v65, s14, v65
    v_add_f32 v248, v248, v64
    v_add_f32 v249, v249, v65
    s_waitcnt lgkmcnt(6)
    v_mfma_f32_32x32x16_bf16 v[160:175], a[40:43], a[112:115], v[160:175]
    ds_read_b64_tr_b16 a[140:141], v56 offset:55296
    ds_read_b64_tr_b16 a[142:143], v57 offset:55296
    v_mul_f32 v120, v120, v120
    v_mul_f32 v121, v121, v121
    v_mfma_f32_32x32x16_bf16 v[160:175], a[44:47], a[116:119], v[160:175]
    ds_read_b64_tr_b16 a[112:113], v56 offset:57344
    ds_read_b64_tr_b16 a[114:115], v57 offset:57344
    v_lshlrev_b32 v250, 16, v229
    v_and_b32 v251, s14, v229
    v_sub_f32 v66, v250, v106
    v_mfma_f32_32x32x16_bf16 v[160:175], a[48:51], a[120:123], v[160:175]
    ds_read_b64_tr_b16 a[116:117], v56 offset:59392
    ds_read_b64_tr_b16 a[118:119], v57 offset:59392
    v_sub_f32 v67, v251, v107
    v_cvt_pk_bf16_f32 v67, v66, v67
    v_lshlrev_b32 v66, 16, v67
    v_mfma_f32_32x32x16_bf16 v[160:175], a[52:55], a[124:127], v[160:175]
    ds_read_b64_tr_b16 a[120:121], v56 offset:61440
    ds_read_b64_tr_b16 a[122:123], v57 offset:61440
    v_and_b32 v67, s14, v67
    v_mul_f32 v66, v66, v122
    v_mul_f32 v67, v67, v123
    s_waitcnt lgkmcnt(6)
    v_mfma_f32_32x32x16_bf16 v[160:175], a[56:59], a[128:131], v[160:175]
    ds_read_b64_tr_b16 a[124:125], v62 offset:49152
    ds_read_b64_tr_b16 a[126:127], v63 offset:49152
    v_cvt_pk_bf16_f32 v67, v66, v67
    v_lshlrev_b32 v66, 16, v67
    v_mfma_f32_32x32x16_bf16 v[160:175], a[60:63], a[132:135], v[160:175]
    ds_read_b64_tr_b16 a[128:129], v62 offset:51200
    ds_read_b64_tr_b16 a[130:131], v63 offset:51200
    v_and_b32 v67, s14, v67
    v_mul_f32 v66, v66, v93
    v_mul_f32 v67, v67, v93
    v_mfma_f32_32x32x16_bf16 v[160:175], a[64:67], a[136:139], v[160:175]
    ds_read_b64_tr_b16 a[132:133], v62 offset:53248
    ds_read_b64_tr_b16 a[134:135], v63 offset:53248
    v_cvt_pk_bf16_f32 v67, v66, v67
    v_lshlrev_b32 v66, 16, v67
    v_and_b32 v67, s14, v67
    v_mfma_f32_32x32x16_bf16 v[160:175], a[68:71], a[140:143], v[160:175]
    ds_read_b64_tr_b16 a[136:137], v62 offset:55296
    ds_read_b64_tr_b16 a[138:139], v63 offset:55296
    v_add_f32 v250, v250, v66
    v_add_f32 v251, v251, v67
    v_mul_f32 v122, v122, v122
    s_waitcnt lgkmcnt(6)
    v_mfma_f32_32x32x16_bf16 v[160:175], a[72:75], a[112:115], v[160:175]
    ds_read_b64_tr_b16 a[140:141], v62 offset:57344
    ds_read_b64_tr_b16 a[142:143], v63 offset:57344
    v_mul_f32 v123, v123, v123
    v_lshlrev_b32 v252, 16, v230
    v_mfma_f32_32x32x16_bf16 v[160:175], a[76:79], a[116:119], v[160:175]
    ds_read_b64_tr_b16 a[112:113], v62 offset:59392
    ds_read_b64_tr_b16 a[114:115], v63 offset:59392
    v_and_b32 v253, s14, v230
    v_sub_f32 v64, v252, v108
    v_sub_f32 v65, v253, v109
    v_mfma_f32_32x32x16_bf16 v[160:175], a[80:83], a[120:123], v[160:175]
    ds_read_b64_tr_b16 a[116:117], v62 offset:61440
    ds_read_b64_tr_b16 a[118:119], v63 offset:61440
    v_cvt_pk_bf16_f32 v65, v64, v65
    v_lshlrev_b32 v64, 16, v65
    v_and_b32 v65, s14, v65
    v_mfma_f32_32x32x16_bf16 v[176:191], a[0:3], a[124:127], v[176:191]
    ds_read_b64_tr_b16 a[120:121], v58 offset:32768
    ds_read_b64_tr_b16 a[122:123], v59 offset:32768
    v_mul_f32 v64, v64, v124
    v_mul_f32 v65, v65, v125
    v_cvt_pk_bf16_f32 v65, v64, v65
    s_waitcnt lgkmcnt(6)
    v_mfma_f32_32x32x16_bf16 v[176:191], a[4:7], a[128:131], v[176:191]
    ds_read_b64_tr_b16 a[124:125], v58 offset:34816
    ds_read_b64_tr_b16 a[126:127], v59 offset:34816
    v_lshlrev_b32 v64, 16, v65
    v_and_b32 v65, s14, v65
    v_mfma_f32_32x32x16_bf16 v[176:191], a[8:11], a[132:135], v[176:191]
    ds_read_b64_tr_b16 a[128:129], v58 offset:36864
    ds_read_b64_tr_b16 a[130:131], v59 offset:36864
    v_cvt_pk_bf16_f32 v204, v160, v161
    v_cvt_pk_bf16_f32 v205, v162, v163
    v_cvt_pk_bf16_f32 v206, v164, v165
    v_mfma_f32_32x32x16_bf16 v[176:191], a[12:15], a[136:139], v[176:191]
    ds_read_b64_tr_b16 a[132:133], v58 offset:38912
    ds_read_b64_tr_b16 a[134:135], v59 offset:38912
    v_cvt_pk_bf16_f32 v207, v166, v167
    v_min_u32 v204, -2, v204
    v_cvt_pk_bf16_f32 v208, v168, v169
    v_mfma_f32_32x32x16_bf16 v[176:191], a[16:19], a[140:143], v[176:191]
    ds_read_b64_tr_b16 a[136:137], v58 offset:40960
    ds_read_b64_tr_b16 a[138:139], v59 offset:40960
    v_cvt_pk_bf16_f32 v209, v170, v171
    v_cvt_pk_bf16_f32 v210, v172, v173
    v_cvt_pk_bf16_f32 v211, v174, v175
    s_waitcnt lgkmcnt(6)
    v_mfma_f32_32x32x16_bf16 v[176:191], a[20:23], a[112:115], v[176:191]
    ds_read_b64_tr_b16 a[140:141], v58 offset:43008
    ds_read_b64_tr_b16 a[142:143], v59 offset:43008
    v_min_u32 v208, -2, v208
    v_mul_f32 v64, v64, v93
    v_mfma_f32_32x32x16_bf16 v[176:191], a[24:27], a[116:119], v[176:191]
    ds_read_b64_tr_b16 a[112:113], v58 offset:45056
    ds_read_b64_tr_b16 a[114:115], v59 offset:45056
    buffer_store_dwordx4 v[204:207], v31, s[80:83], s27 offen offset:0 sc1
    v_mul_f32 v65, v65, v93
    v_cvt_pk_bf16_f32 v65, v64, v65
    v_mfma_f32_32x32x16_bf16 v[176:191], a[28:31], a[120:123], v[176:191]
    ds_read_b64_tr_b16 a[116:117], v58 offset:49152
    ds_read_b64_tr_b16 a[118:119], v59 offset:49152
    v_lshlrev_b32 v64, 16, v65
    v_and_b32 v65, s14, v65
    v_add_f32 v252, v252, v64
    v_mfma_f32_32x32x16_bf16 v[176:191], a[32:35], a[124:127], v[176:191]
    ds_read_b64_tr_b16 a[120:121], v58 offset:51200
    ds_read_b64_tr_b16 a[122:123], v59 offset:51200
    buffer_store_dwordx4 v[208:211], v31, s[80:83], s27 offen offset:1024 sc1
    v_add_f32 v253, v253, v65
    v_mul_f32 v124, v124, v124
    s_waitcnt lgkmcnt(6)
    v_mfma_f32_32x32x16_bf16 v[176:191], a[36:39], a[128:131], v[176:191]
    ds_read_b64_tr_b16 a[124:125], v58 offset:53248
    ds_read_b64_tr_b16 a[126:127], v59 offset:53248
    v_mul_f32 v125, v125, v125
    v_lshlrev_b32 v254, 16, v231
    v_mfma_f32_32x32x16_bf16 v[176:191], a[40:43], a[132:135], v[176:191]
    ds_read_b64_tr_b16 a[128:129], v58 offset:55296
    ds_read_b64_tr_b16 a[130:131], v59 offset:55296
    v_and_b32 v255, s14, v231
    v_sub_f32 v66, v254, v110
    v_sub_f32 v67, v255, v111
    v_mfma_f32_32x32x16_bf16 v[176:191], a[44:47], a[136:139], v[176:191]
    ds_read_b64_tr_b16 a[132:133], v58 offset:57344
    ds_read_b64_tr_b16 a[134:135], v59 offset:57344
    v_cvt_pk_bf16_f32 v67, v66, v67
    v_lshlrev_b32 v66, 16, v67
    v_and_b32 v67, s14, v67
    v_mfma_f32_32x32x16_bf16 v[176:191], a[48:51], a[140:143], v[176:191]
    ds_read_b64_tr_b16 a[136:137], v58 offset:59392
    ds_read_b64_tr_b16 a[138:139], v59 offset:59392
    v_mul_f32 v66, v66, v126
    v_mul_f32 v67, v67, v127
    v_cvt_pk_bf16_f32 v67, v66, v67
    s_waitcnt lgkmcnt(6)
    v_mfma_f32_32x32x16_bf16 v[176:191], a[52:55], a[112:115], v[176:191]
    ds_read_b64_tr_b16 a[140:141], v58 offset:61440
    ds_read_b64_tr_b16 a[142:143], v59 offset:61440
    buffer_load_dwordx4 v[128:131], v31, s[80:83], s28 offen offset:0 sc1
    v_lshlrev_b32 v66, 16, v67
    v_mfma_f32_32x32x16_bf16 v[176:191], a[56:59], a[116:119], v[176:191]
    ds_read_b128 a[112:115], v54 offset:24576
    buffer_load_dwordx4 v[132:135], v31, s[80:83], s28 offen offset:1024 sc1
    v_and_b32 v67, s14, v67
    v_mul_f32 v66, v66, v93
    v_mul_f32 v67, v67, v93
    v_mfma_f32_32x32x16_bf16 v[176:191], a[60:63], a[120:123], v[176:191]
    ds_read_b128 a[116:119], v55 offset:24576
    buffer_load_dwordx4 v[136:139], v31, s[80:83], s28 offen offset:2048 sc1
    v_cvt_pk_bf16_f32 v67, v66, v67
    v_lshlrev_b32 v66, 16, v67
    v_and_b32 v67, s14, v67
    v_mfma_f32_32x32x16_bf16 v[176:191], a[64:67], a[124:127], v[176:191]
    ds_read_b128 a[120:123], v22 offset:24576
    v_add_f32 v254, v254, v66
    v_add_f32 v255, v255, v67
    v_mul_f32 v126, v126, v126
    v_mul_f32 v127, v127, v127
    s_waitcnt lgkmcnt(3)
    v_mfma_f32_32x32x16_bf16 v[176:191], a[68:71], a[128:131], v[176:191]
    ds_read_b128 a[124:127], v23 offset:24576
    v_mfma_f32_32x32x16_bf16 v[176:191], a[72:75], a[132:135], v[176:191]
    ds_read_b128 a[128:131], v52 offset:28672
    v_mfma_f32_32x32x16_bf16 v[176:191], a[76:79], a[136:139], v[176:191]
    ds_read_b128 a[132:135], v53 offset:28672
    v_mfma_f32_32x32x16_bf16 v[176:191], a[80:83], a[140:143], v[176:191]
    ds_read_b128 a[136:139], v20 offset:28672
    s_waitcnt lgkmcnt(3)
    v_mfma_f32_32x32x16_bf16 v[176:191], a[160:163], a[112:115], v[176:191]
    ds_read_b128 a[140:143], v21 offset:28672
    v_mfma_f32_32x32x16_bf16 v[176:191], a[164:167], a[116:119], v[176:191]
    ds_read_b128 a[112:115], v54 offset:28672
    v_mfma_f32_32x32x16_bf16 v[176:191], a[168:171], a[120:123], v[176:191]
    ds_read_b128 a[116:119], v55 offset:28672
    v_mfma_f32_32x32x16_bf16 v[176:191], a[172:175], a[124:127], v[176:191]
    ds_read_b128 a[120:123], v22 offset:28672
    s_waitcnt lgkmcnt(3)
    v_mfma_f32_32x32x16_bf16 v[176:191], a[176:179], a[128:131], v[176:191]
    ds_read_b128 a[124:127], v23 offset:28672
    v_mfma_f32_32x32x16_bf16 v[176:191], a[180:183], a[132:135], v[176:191]
    ds_read_b128 a[128:131], v52 offset:24576
    v_mfma_f32_32x32x16_bf16 v[176:191], a[184:187], a[136:139], v[176:191]
    ds_read_b128 a[132:135], v53 offset:24576
    v_mfma_f32_32x32x16_bf16 v[176:191], a[188:191], a[140:143], v[176:191]
    ds_read_b128 a[136:139], v20 offset:24576
    s_waitcnt lgkmcnt(3)
    v_mfma_f32_32x32x16_bf16 v[176:191], a[192:195], a[112:115], v[176:191]
    ds_read_b128 a[140:143], v21 offset:24576
    buffer_load_dwordx4 v[140:143], v31, s[80:83], s28 offen offset:3072 sc1
    v_mfma_f32_32x32x16_bf16 v[176:191], a[196:199], a[116:119], v[176:191]
    buffer_load_dwordx4 v[144:147], v88, s[80:83], s28 offen offset:0 sc1
    v_mfma_f32_32x32x16_bf16 v[176:191], a[200:203], a[120:123], v[176:191]
    v_mfma_f32_32x32x16_bf16 v[176:191], a[204:207], a[124:127], v[176:191]
    s_waitcnt lgkmcnt(0)
    v_mfma_f32_32x32x16_bf16 v[176:191], a[144:147], a[128:131], v[176:191]
    v_mfma_f32_32x32x16_bf16 v[176:191], a[148:151], a[132:135], v[176:191]
    v_mfma_f32_32x32x16_bf16 v[176:191], a[152:155], a[136:139], v[176:191]
    v_mfma_f32_32x32x16_bf16 v[176:191], a[156:159], a[140:143], v[176:191]
    buffer_load_dwordx4 v[72:75], v88, s[80:83], s28 offen offset:2048 sc1
    buffer_load_dwordx4 v[76:79], v88, s[80:83], s28 offen offset:3072 sc1
    s_waitcnt vmcnt(2)
    v_mov_b32 v64, 0
    v_max_u32 v65, v140, v144
    v_add_co_u32 v65, vcc, 1, v65
    s_nop 1
    v_addc_co_u32 v64, vcc, 0, v64, vcc
    v_bitop3_b32 v64, v64, v131, s41 bitop3:0xf6
    v_bitop3_b32 v64, v64, v135, s41 bitop3:0xf6
    v_bitop3_b32 v64, v64, v139, s41 bitop3:0xf6
    v_cmp_ne_u32 vcc, 0, v64
    s_nop 0
    s_cbranch_vccnz L_slow_pe
L_back_pe:
    v_lshlrev_b32 v160, 16, v128
    v_and_b32 v161, s14, v128
    v_pk_add_f32 v[176:177], v[176:177], v[160:161]
    v_lshlrev_b32 v162, 16, v129
    v_and_b32 v163, s14, v129
    v_pk_add_f32 v[178:179], v[178:179], v[162:163]
    v_lshlrev_b32 v164, 16, v130
    v_and_b32 v165, s14, v130
    v_pk_add_f32 v[180:181], v[180:181], v[164:165]
    v_lshlrev_b32 v166, 16, v132
    v_and_b32 v167, s14, v132
    v_pk_add_f32 v[182:183], v[182:183], v[166:167]
    v_lshlrev_b32 v168, 16, v133
    v_and_b32 v169, s14, v133
    v_pk_add_f32 v[184:185], v[184:185], v[168:169]
    v_lshlrev_b32 v170, 16, v134
    v_and_b32 v171, s14, v134
    v_pk_add_f32 v[186:187], v[186:187], v[170:171]
    v_lshlrev_b32 v172, 16, v136
    v_and_b32 v173, s14, v136
    v_pk_add_f32 v[188:189], v[188:189], v[172:173]
    v_lshlrev_b32 v174, 16, v137
    v_and_b32 v175, s14, v137
    v_pk_add_f32 v[190:191], v[190:191], v[174:175]
    v_lshlrev_b32 v160, 16, v140
    v_and_b32 v161, s14, v140
    v_pk_add_f32 v[176:177], v[176:177], v[160:161]
    v_lshlrev_b32 v162, 16, v141
    v_and_b32 v163, s14, v141
    v_pk_add_f32 v[178:179], v[178:179], v[162:163]
    v_lshlrev_b32 v164, 16, v142
    v_and_b32 v165, s14, v142
    v_pk_add_f32 v[180:181], v[180:181], v[164:165]
    v_lshlrev_b32 v166, 16, v143
    v_and_b32 v167, s14, v143
    v_pk_add_f32 v[182:183], v[182:183], v[166:167]
    v_lshlrev_b32 v168, 16, v144
    v_and_b32 v169, s14, v144
    v_pk_add_f32 v[184:185], v[184:185], v[168:169]
    v_lshlrev_b32 v170, 16, v145
    v_and_b32 v171, s14, v145
    v_pk_add_f32 v[186:187], v[186:187], v[170:171]
    v_lshlrev_b32 v172, 16, v146
    v_and_b32 v173, s14, v146
    v_pk_add_f32 v[188:189], v[188:189], v[172:173]
    v_lshlrev_b32 v174, 16, v147
    v_and_b32 v175, s14, v147
    v_pk_add_f32 v[190:191], v[190:191], v[174:175]
    v_pk_fma_f32 v[240:241], v[176:177], v[112:113], v[240:241]
    v_pk_fma_f32 v[242:243], v[178:179], v[114:115], v[242:243]
    v_pk_fma_f32 v[244:245], v[180:181], v[116:117], v[244:245]
    v_pk_fma_f32 v[246:247], v[182:183], v[118:119], v[246:247]
    v_pk_fma_f32 v[248:249], v[184:185], v[120:121], v[248:249]
    v_pk_fma_f32 v[250:251], v[186:187], v[122:123], v[250:251]
    v_pk_fma_f32 v[252:253], v[188:189], v[124:125], v[252:253]
    v_pk_fma_f32 v[254:255], v[190:191], v[126:127], v[254:255]
    s_waitcnt vmcnt(0)
    v_mov_b32 v64, 0
    v_max_u32 v65, v72, v76
    v_add_co_u32 v65, vcc, 1, v65
    s_nop 1
    v_addc_co_u32 v64, vcc, 0, v64, vcc
    v_cmp_ne_u32 vcc, 0, v64
    s_nop 0
    s_cbranch_vccnz L_slow_pl
L_back_pl:
    v_lshlrev_b32 v160, 16, v72
    v_and_b32 v161, s14, v72
    v_pk_fma_f32 v[240:241], v[160:161], v[112:113], v[240:241]
    buffer_store_dword v240, v92, s[76:79], s36 offen offset:0
    buffer_store_dword v241, v92, s[76:79], s36 offen offset:2048
    s_add_u32 s36, s36, 4096
    v_lshlrev_b32 v162, 16, v73
    v_and_b32 v163, s14, v73
    v_pk_fma_f32 v[242:243], v[162:163], v[114:115], v[242:243]
    buffer_store_dword v242, v92, s[76:79], s36 offen offset:0
    buffer_store_dword v243, v92, s[76:79], s36 offen offset:2048
    s_add_u32 s36, s36, 4096
    v_lshlrev_b32 v164, 16, v74
    v_and_b32 v165, s14, v74
    v_pk_fma_f32 v[244:245], v[164:165], v[116:117], v[244:245]
    buffer_store_dword v244, v92, s[76:79], s36 offen offset:0
    buffer_store_dword v245, v92, s[76:79], s36 offen offset:2048
    s_add_u32 s36, s36, 4096
    v_lshlrev_b32 v166, 16, v75
    v_and_b32 v167, s14, v75
    v_pk_fma_f32 v[246:247], v[166:167], v[118:119], v[246:247]
    buffer_store_dword v246, v92, s[76:79], s36 offen offset:0
    buffer_store_dword v247, v92, s[76:79], s36 offen offset:2048
    s_add_u32 s36, s36, 4096
    v_lshlrev_b32 v168, 16, v76
    v_and_b32 v169, s14, v76
    v_pk_fma_f32 v[248:249], v[168:169], v[120:121], v[248:249]
    buffer_store_dword v248, v92, s[76:79], s36 offen offset:0
    buffer_store_dword v249, v92, s[76:79], s36 offen offset:2048
    s_add_u32 s36, s36, 4096
    v_lshlrev_b32 v170, 16, v77
    v_and_b32 v171, s14, v77
    v_pk_fma_f32 v[250:251], v[170:171], v[122:123], v[250:251]
    buffer_store_dword v250, v92, s[76:79], s36 offen offset:0
    buffer_store_dword v251, v92, s[76:79], s36 offen offset:2048
    s_add_u32 s36, s36, 4096
    v_lshlrev_b32 v172, 16, v78
    v_and_b32 v173, s14, v78
    v_pk_fma_f32 v[252:253], v[172:173], v[124:125], v[252:253]
    buffer_store_dword v252, v92, s[76:79], s36 offen offset:0
    buffer_store_dword v253, v92, s[76:79], s36 offen offset:2048
    s_add_u32 s36, s36, 4096
    v_lshlrev_b32 v174, 16, v79
    v_and_b32 v175, s14, v79
    v_pk_fma_f32 v[254:255], v[174:175], v[126:127], v[254:255]
    buffer_store_dword v254, v92, s[76:79], s36 offen offset:0
    buffer_store_dword v255, v92, s[76:79], s36 offen offset:2048
    s_add_u32 s36, s36, 4096
    s_endpgm
L_slow_n:
    s_mov_b32 s12, 0
    s_branch L_go_n
L_spin_n:
    s_sleep 1
L_go_n:
    global_load_dword v50, v51, s[44:45] sc1
    s_waitcnt vmcnt(0)
    v_cmp_eq_u32 vcc, 0, v50
    s_add_u32 s12, s12, 1
    s_cmp_gt_u32 s12, 20000
    s_cbranch_scc1 L_out_n
    s_cbranch_vccnz L_spin_n
L_out_n:
    s_mov_b64 exec, -1
    s_nop 4
    s_branch L_back_n
L_slow_e:
    s_mov_b32 s12, 0
    s_branch L_go_e
L_spin_e:
    s_sleep 1
L_go_e:
    buffer_load_dwordx3 v[72:74], v68, s[84:87], 0 offen sc1
    buffer_load_dwordx3 v[76:78], v69, s[84:87], 0 offen sc1
    s_waitcnt vmcnt(0)
    v_xor_b32 v64, s41, v74
    v_bitop3_b32 v64, v64, v78, s41 bitop3:0xf6
    v_cmp_ne_u32 vcc, 0, v64
    s_add_u32 s12, s12, 1
    s_cmp_gt_u32 s12, 20000
    s_cbranch_scc1 L_out_e
    s_cbranch_vccnz L_spin_e
L_out_e:
    s_mov_b64 exec, -1
    s_nop 4
    s_branch L_back_e
L_slow_ps:
    s_mov_b32 s12, 0
    s_mov_b64 exec, 31
    s_branch L_go_ps
L_spin_ps:
    s_sleep 1
L_go_ps:
    buffer_load_dword v94, v35, s[80:83], 0 offen offset:4 sc1
    s_waitcnt vmcnt(0)
    v_cmp_ne_u32 vcc, s41, v94
    s_add_u32 s12, s12, 1
    s_cmp_gt_u32 s12, 20000
    s_cbranch_scc1 L_out_ps
    s_cbranch_vccnz L_spin_ps
L_out_ps:
    s_mov_b64 exec, -1
    s_nop 4
    s_branch L_back_ps
L_slow_hf1:
    s_mov_b32 s12, 0
    s_branch L_go_hf1
L_spin_hf1:
    s_sleep 1
L_go_hf1:
    buffer_load_dwordx4 a[0:3], v88, s[80:83], s22 offen offset:0 sc1
    buffer_load_dwordx4 a[4:7], v88, s[80:83], s22 offen offset:1024 sc1
    buffer_load_dwordx4 a[8:11], v88, s[80:83], s22 offen offset:2048 sc1
    buffer_load_dwordx4 a[12:15], v88, s[80:83], s22 offen offset:3072 sc1
    buffer_load_dwordx4 a[16:19], v89, s[80:83], s22 offen offset:0 sc1
    buffer_load_dwordx4 a[20:23], v89, s[80:83], s22 offen offset:1024 sc1
    buffer_load_dwordx4 a[24:27], v89, s[80:83], s22 offen offset:2048 sc1
    s_waitcnt vmcnt(0)
    v_accvgpr_read_b32 v72, a0
    v_accvgpr_read_b32 v73, a4
    v_accvgpr_read_b32 v74, a8
    v_accvgpr_read_b32 v75, a12
    v_accvgpr_read_b32 v76, a16
    v_accvgpr_read_b32 v77, a20
    v_accvgpr_read_b32 v78, a24
    v_max3_u32 v72, v72, v73, v74
    v_max3_u32 v75, v75, v76, v77
    v_max3_u32 v72, v72, v75, v78
    v_cmp_eq_u32 vcc, -1, v72
    s_add_u32 s12, s12, 1
    s_cmp_gt_u32 s12, 20000
    s_cbranch_scc1 L_out_hf1
    s_cbranch_vccnz L_spin_hf1
L_out_hf1:
    s_mov_b64 exec, -1
    s_nop 4
    s_branch L_back_hf1
L_slow_hf2:
    s_mov_b32 s12, 0
    s_branch L_go_hf2
L_spin_hf2:
    s_sleep 1
L_go_hf2:
    buffer_load_dwordx4 a[28:31], v88, s[80:83], s23 offen offset:0 sc1
    buffer_load_dwordx4 a[32:35], v88, s[80:83], s23 offen offset:1024 sc1
    buffer_load_dwordx4 a[36:39], v88, s[80:83], s23 offen offset:2048 sc1
    buffer_load_dwordx4 a[40:43], v88, s[80:83], s23 offen offset:3072 sc1
    buffer_load_dwordx4 a[44:47], v89, s[80:83], s23 offen offset:0 sc1
    buffer_load_dwordx4 a[48:51], v89, s[80:83], s23 offen offset:1024 sc1
    buffer_load_dwordx4 a[52:55], v89, s[80:83], s23 offen offset:2048 sc1
    s_waitcnt vmcnt(0)
    v_accvgpr_read_b32 v72, a28
    v_accvgpr_read_b32 v73, a32
    v_accvgpr_read_b32 v74, a36
    v_accvgpr_read_b32 v75, a40
    v_accvgpr_read_b32 v76, a44
    v_accvgpr_read_b32 v77, a48
    v_accvgpr_read_b32 v78, a52
    v_max3_u32 v72, v72, v73, v74
    v_max3_u32 v75, v75, v76, v77
    v_max3_u32 v72, v72, v75, v78
    v_cmp_eq_u32 vcc, -1, v72
    s_add_u32 s12, s12, 1
    s_cmp_gt_u32 s12, 20000
    s_cbranch_scc1 L_out_hf2
    s_cbranch_vccnz L_spin_hf2
L_out_hf2:
    s_mov_b64 exec, -1
    s_nop 4
    s_branch L_back_hf2
L_slow_hf3:
    s_mov_b32 s12, 0
    s_branch L_go_hf3
L_spin_hf3:
    s_sleep 1
L_go_hf3:
    buffer_load_dwordx4 a[56:59], v88, s[80:83], s24 offen offset:0 sc1
    buffer_load_dwordx4 a[60:63], v88, s[80:83], s24 offen offset:1024 sc1
    buffer_load_dwordx4 a[64:67], v88, s[80:83], s24 offen offset:2048 sc1
    buffer_load_dwordx4 a[68:71], v88, s[80:83], s24 offen offset:3072 sc1
    buffer_load_dwordx4 a[72:75], v89, s[80:83], s24 offen offset:0 sc1
    buffer_load_dwordx4 a[76:79], v89, s[80:83], s24 offen offset:1024 sc1
    buffer_load_dwordx4 a[80:83], v89, s[80:83], s24 offen offset:2048 sc1
    s_waitcnt vmcnt(0)
    v_accvgpr_read_b32 v72, a56
    v_accvgpr_read_b32 v73, a60
    v_accvgpr_read_b32 v74, a64
    v_accvgpr_read_b32 v75, a68
    v_accvgpr_read_b32 v76, a72
    v_accvgpr_read_b32 v77, a76
    v_accvgpr_read_b32 v78, a80
    v_max3_u32 v72, v72, v73, v74
    v_max3_u32 v75, v75, v76, v77
    v_max3_u32 v72, v72, v75, v78
    v_cmp_eq_u32 vcc, -1, v72
    s_add_u32 s12, s12, 1
    s_cmp_gt_u32 s12, 20000
    s_cbranch_scc1 L_out_hf3
    s_cbranch_vccnz L_spin_hf3
L_out_hf3:
    s_mov_b64 exec, -1
    s_nop 4
    s_branch L_back_hf3
L_slow_pe:
    s_mov_b32 s12, 0
    s_branch L_go_pe
L_spin_pe:
    s_sleep 1
L_go_pe:
    buffer_load_dwordx4 v[128:131], v31, s[80:83], s28 offen offset:0 sc1
    buffer_load_dwordx4 v[132:135], v31, s[80:83], s28 offen offset:1024 sc1
    buffer_load_dwordx4 v[136:139], v31, s[80:83], s28 offen offset:2048 sc1
    buffer_load_dwordx4 v[140:143], v31, s[80:83], s28 offen offset:3072 sc1
    buffer_load_dwordx4 v[144:147], v88, s[80:83], s28 offen offset:0 sc1
    s_waitcnt vmcnt(0)
    v_mov_b32 v64, 0
    v_max_u32 v65, v140, v144
    v_add_co_u32 v65, vcc, 1, v65
    s_nop 1
    v_addc_co_u32 v64, vcc, 0, v64, vcc
    v_bitop3_b32 v64, v64, v131, s41 bitop3:0xf6
    v_bitop3_b32 v64, v64, v135, s41 bitop3:0xf6
    v_bitop3_b32 v64, v64, v139, s41 bitop3:0xf6
    v_cmp_ne_u32 vcc, 0, v64
    s_add_u32 s12, s12, 1
    s_cmp_gt_u32 s12, 20000
    s_cbranch_scc1 L_out_pe
    s_cbranch_vccnz L_spin_pe
L_out_pe:
    s_mov_b64 exec, -1
    s_nop 4
    s_branch L_back_pe
L_slow_pl:
    s_mov_b32 s12, 0
    s_branch L_go_pl
L_spin_pl:
    s_sleep 1
L_go_pl:
    buffer_load_dwordx4 v[72:75], v88, s[80:83], s28 offen offset:2048 sc1
    buffer_load_dwordx4 v[76:79], v88, s[80:83], s28 offen offset:3072 sc1
    s_waitcnt vmcnt(0)
    v_mov_b32 v64, 0
    v_max_u32 v65, v72, v76
    v_add_co_u32 v65, vcc, 1, v65
    s_nop 1
    v_addc_co_u32 v64, vcc, 0, v64, vcc
    v_cmp_ne_u32 vcc, 0, v64
    s_add_u32 s12, s12, 1
    s_cmp_gt_u32 s12, 20000
    s_cbranch_scc1 L_out_pl
    s_cbranch_vccnz L_spin_pl
L_out_pl:
    s_mov_b64 exec, -1
    s_nop 4
    s_branch L_back_pl
L_end:
    s_endpgm
.section .rodata,"a"
.p2align 6
.amdhsa_kernel parallel_sum__ssm_conv_s5__glu_gated_bilinear__prompt_kernel
  .amdhsa_next_free_vgpr 512
  .amdhsa_next_free_sgpr 102
  .amdhsa_accum_offset 256
  .amdhsa_group_segment_fixed_size 0
  .amdhsa_kernarg_size 128
  .amdhsa_user_sgpr_count 2
  .amdhsa_user_sgpr_kernarg_segment_ptr 1
  .amdhsa_system_sgpr_workgroup_id_x 1
.end_amdhsa_kernel
```
